```python
import torch

def _softmax(x, axis=-1):
    return torch.softmax(x, dim=axis)
def _gelu(x):
    return torch.nn.functional.gelu(x, approximate="tanh")
def _silu(x):
    return torch.nn.functional.silu(x)
def _sigmoid(x):
    return torch.sigmoid(x)
def _layernorm(x, axis=-1, eps=1e-5):
    m = x.mean(dim=axis, keepdim=True)
    v = x.var(dim=axis, keepdim=True, unbiased=False)
    return (x - m) / torch.sqrt(v + eps)
def _scatter_add(tgt, idx, src, axis=0):
    return tgt.clone().index_add_(axis, idx, src)
def _segment_sum(src, seg, n):
    out = torch.zeros((n,) + src.shape[1:], dtype=src.dtype)
    return out.index_add_(0, seg, src)
def _pad(x, pw):
    flat = tuple(v for pair in reversed(pw) for v in pair)
    return torch.nn.functional.pad(x, flat)

kernel_name = 'parallel_sum__spectral_fnet__glu_gated_glu__prompt'

def setup_inputs():

    _w = (lambda a: (lambda t: t.to(torch.bfloat16) if t.is_floating_point() else t)(torch.as_tensor(a)))
    def _A_setup():
        B, S, D = 1, 2048, 512
        ns = torch.arange(S)[:, None] * torch.arange(S)[None, :]
        nd = torch.arange(D)[:, None] * torch.arange(D)[None, :]
        Ws_re = torch.cos(-2.0 * torch.pi * ns / S).to(float)
        Ws_im = torch.sin(-2.0 * torch.pi * ns / S).to(float)
        Wd_re = torch.cos(-2.0 * torch.pi * nd / D).to(float)
        Wd_im = torch.sin(-2.0 * torch.pi * nd / D).to(float)
        return {
            "x": _w((lambda *s: torch.randn(*s, dtype=torch.bfloat16) * 0.05)(B, S, D)),
            "dft_seq_re": _w(Ws_re),
            "dft_seq_im": _w(Ws_im),
            "dft_hid_re": _w(Wd_re),
            "dft_hid_im": _w(Wd_im),
        }
    _A_in = _A_setup()

    def _B_setup():
        B, S, D, F = 1, 2048, 512, 1792
        return {
            "x": _w((lambda *s: torch.randn(*s, dtype=torch.bfloat16) * 0.05)(B, S, D)),
            "w_gate": _w((lambda *s: torch.randn(*s, dtype=torch.bfloat16) * 1.6)(D, F)),
            "w_up": _w((lambda *s: torch.randn(*s, dtype=torch.bfloat16) * 0.8)(D, F)),
            "w_down": _w((lambda *s: torch.randn(*s, dtype=torch.bfloat16) * 0.8)(F, D)),
        }
    _B_in = _B_setup()

    return {
        "A_x": _A_in["x"],
        "A_dft_seq_re": _A_in["dft_seq_re"],
        "A_dft_seq_im": _A_in["dft_seq_im"],
        "A_dft_hid_re": _A_in["dft_hid_re"],
        "A_dft_hid_im": _A_in["dft_hid_im"],
        "B_x": _B_in["x"],
        "B_w_gate": _B_in["w_gate"],
        "B_w_up": _B_in["w_up"],
        "B_w_down": _B_in["w_down"],
    }

def reference(A_x, A_dft_seq_re, A_dft_seq_im, A_dft_hid_re, A_dft_hid_im, B_x, B_w_gate, B_w_up, B_w_down):
    def _A_ref(x, dft_seq_re, dft_seq_im, dft_hid_re, dft_hid_im):
        a = torch.einsum("bsd,ed->bse", x, dft_hid_re)
        b = torch.einsum("bsd,ed->bse", x, dft_hid_im)
        y = torch.einsum("ts,bse->bte", dft_seq_re, a) - torch.einsum("ts,bse->bte", dft_seq_im, b)
        return y

    def _B_ref(x, w_gate, w_up, w_down):
        g = torch.einsum("bsd,df->bsf", x, w_gate)
        u = torch.einsum("bsd,df->bsf", x, w_up)
        h = _sigmoid(g) * u
        return torch.einsum("bsf,fd->bsd", h, w_down)

    x = A_x
    xn = _layernorm(x, axis=-1)
    return x + _A_ref(xn, A_dft_seq_re, A_dft_seq_im, A_dft_hid_re, A_dft_hid_im) + _B_ref(xn, B_w_gate, B_w_up, B_w_down)
```

```asm
; @launch grid=(256,1,1) block=(256,1,1) lds=163840
.amdgcn_target "amdgcn-amd-amdhsa--gfx950"
.text
.p2align 12
.globl parallel_sum__spectral_fnet__glu_gated_glu__prompt_kernel
.p2align 8
.type parallel_sum__spectral_fnet__glu_gated_glu__prompt_kernel,@function
parallel_sum__spectral_fnet__glu_gated_glu__prompt_kernel:
    s_cmp_ge_u32 s2, 256
    s_cbranch_scc1 L_end
    s_load_dwordx2 s[4:5], s[0:1], 0
    s_load_dwordx4 s[8:11], s[0:1], 24
    s_load_dwordx4 s[12:15], s[0:1], 48
    s_load_dwordx8 s[72:79], s[0:1], 64
    s_getpc_b64 s[80:81]
L_pc:
    s_lshr_b32 s48, s2, 3
    s_mul_i32 s48, s48, 1152
    v_min_u32 v4, 8, v0
    v_lshl_add_u32 v4, v4, 7, s48
    v_min_u32 v4, L_code_end-L_pc-4, v4
    global_load_dword v46, v4, s[80:81]
    v_and_b32 v1, 63, v0
    v_lshrrev_b32 v4, 6, v0
    v_and_b32 v2, 15, v0
    v_readfirstlane_b32 s44, v4
    v_bfe_u32 v3, v0, 4, 2
    s_lshr_b32 s48, s2, 2
    s_xor_b32 s48, s48, s2
    s_and_b32 s48, s48, 1
    s_mul_i32 s48, s48, 5
    s_xor_b32 s2, s2, s48
    s_and_b32 s48, s2, 1
    s_lshl_b32 s48, s48, 3
    s_bfe_u32 s45, s2, 196611
    s_add_u32 s45, s45, s48
    s_bfe_u32 s48, s2, 131073
    s_lshr_b32 s49, s2, 6
    s_mul_i32 s46, s48, 3
    s_add_u32 s46, s46, s49
    s_add_u32 s50, s48, 14
    s_cmp_eq_u32 s49, 3
    s_cselect_b32 s50, s50, s46
    s_cmp_eq_u32 s48, 3
    s_addc_u32 s46, s46, 0
    s_cmp_lt_u32 s48, 2
    s_cselect_b32 s46, s50, s46
    s_xor_b32 s48, s45, s49
    s_and_b32 s48, s48, 1
    s_lshl_b32 s68, s48, 1
    s_lshr_b32 s48, s2, 1
    s_xor_b32 s48, s48, s2
    s_and_b32 s48, s48, 1
    s_add_u32 s68, s68, s48
    s_lshl_b32 s70, s68, 8
    s_or_b32 s68, s68, 4
    s_mov_b32 s69, s68
    s_sub_u32 s49, 32, s45
    s_cmp_eq_u32 s45, 0
    s_cselect_b32 s49, 16, s49
    s_bitcmp1_b32 s44, 1
    s_cselect_b32 s48, s49, s45
    s_sub_u32 s49, 64, s48
    s_cmp_eq_u32 s48, 0
    s_cselect_b32 s49, 32, s49
    s_add_u32 s50, s48, 32
    s_movk_i32 s54, 3584
    s_cmp_ge_u32 s46, 14
    s_cselect_b32 s49, s50, s49
    s_cselect_b32 s54, 1024, s54
    s_cselect_b32 s52, 12, 0
    s_sub_u32 s52, s46, s52
    s_lshl_b32 s52, s52, 8
    s_bitcmp1_b32 s44, 0
    s_cselect_b32 s48, s49, s48
    s_cselect_b32 s53, 8, 0
    s_lshl_b32 s48, s48, 10
    v_lshrrev_b32 v4, 3, v1
    v_lshl_add_u32 v4, v4, 16, s48
    v_and_b32 v6, 7, v1
    v_xor_b32 v6, v6, v3
    v_lshl_add_u32 v16, v6, 4, v4
    v_xor_b32_e64 v7, 64, v16
    v_add_u32 v17, 523264, v7
    v_add_u32 v18, 1046528, v16
    v_add_u32 v19, 1569792, v7
    s_lshl_b32 s64, s44, 12
    s_lshl_b32 s67, s54, 5
    s_mov_b32 s22, 2097152
    s_mov_b32 s23, 0x20000
    s_lshl_b32 s49, s44, 3
    v_add_u32 v4, s49, v3
    v_mul_u32_u24 v4, s54, v4
    v_add_u32 v4, s52, v4
    v_lshl_add_u32 v7, v3, 1, s53
    v_xor_b32_e64 v6, v2, v7
    v_lshl_add_u32 v20, v6, 4, v4
    s_lshl_b32 s49, s54, 2
    s_sub_u32 s49, s49, 1024
    v_add_u32 v21, s49, v20
    s_cmp_lt_u32 s46, 14
    s_cbranch_scc1 L_wglu
    s_lshl_b32 s49, s44, 6
    s_add_u32 s49, s49, s46
    s_add_u32 s49, s49, 242
    s_lshl_b32 s49, s49, 10
    v_lshrrev_b32 v4, 3, v1
    v_lshl_add_u32 v4, v4, 11, s49
    v_and_b32 v6, 0x70, v16
    v_add_u32 v20, v6, v4
    v_xor_b32 v7, 64, v20
    v_add_u32 v21, 15360, v7
L_wglu:
    s_lshl_b32 s26, s54, 9
    s_mov_b32 s27, 0x20000
    s_add_u32 s30, s26, 2048
    s_mov_b32 s31, 0x20000
    s_add_u32 m0, s64, 0
    s_lshl_b32 s65, s68, 7
    s_waitcnt lgkmcnt(0)
    s_mov_b64 s[20:21], s[4:5]
    buffer_load_dwordx4 v16, s[20:23], s65 offen offset:0 lds
    s_cmp_ge_u32 s46, 14
    s_cselect_b64 s[24:25], s[8:9], s[12:13]
    s_cselect_b64 s[28:29], s[10:11], s[14:15]
    buffer_load_dwordx4 v17, s[20:23], s65 offen offset:1024 lds
    s_sub_u32 s28, s28, 2048
    s_subb_u32 s29, s29, 0
    buffer_load_dwordx4 v18, s[20:23], s65 offen offset:2048 lds
    s_lshl_b32 s15, s67, 1
    s_cmp_ge_u32 s46, 14
    s_cselect_b32 s15, 128, s15
    s_mul_i32 s0, s67, -9
    buffer_load_dwordx4 v19, s[20:23], s65 offen offset:3072 lds
    s_add_u32 m0, s64, 65536
    s_mul_i32 s66, s69, s15
    buffer_load_dwordx4 v20, s[24:27], s66 offen offset:0 lds
    buffer_load_dwordx4 v21, s[24:27], s66 offen offset:1024 lds
    buffer_load_dwordx4 v20, s[28:31], s66 offen offset:2048 lds
    buffer_load_dwordx4 v21, s[28:31], s66 offen offset:3072 lds
    s_add_u32 m0, s64, 81920
    s_add_u32 s66, s66, s67
    buffer_load_dwordx4 v20, s[24:27], s66 offen offset:0 lds
    s_add_u32 s69, s69, 1
    s_and_b32 s69, s69, 3
    s_or_b32 s69, s69, 4
    buffer_load_dwordx4 v21, s[24:27], s66 offen offset:1024 lds
    s_mov_b64 s[32:33], s[78:79]
    s_mov_b32 s34, 11075584
    s_mov_b32 s35, 0x20000
    s_lshl_b32 s51, s2, 9
    s_add_u32 s51, s51, 10485760
    s_and_b32 s49, s2, 0xc7
    s_cselect_b32 s51, 2130706432, s51
    s_mov_b32 s87, 1
    v_mov_b32 v4, 0
    v_mov_b32 v5, 0
    v_mov_b32 v6, 0
    v_mov_b32 v7, 0
    v_lshlrev_b32_e64 v8, 4, v0
    v_mov_b32 v10, 2130706432
    buffer_store_dwordx4 v[4:7], v8, s[32:35], s51 offen sc1
    v_mov_b32 v11, 0
    s_mov_b64 s[36:37], s[72:73]
    s_mov_b32 s38, 1835008
    s_mov_b32 s39, 0x20000
    s_mov_b64 s[40:41], s[74:75]
    s_mov_b32 s42, 2097152
    s_mov_b32 s43, 0x20000
    v_lshrrev_b32 v4, 1, v2
    v_xor_b32 v4, v4, v3
    v_lshlrev_b32 v4, 4, v4
    v_lshl_add_u32 v26, v2, 7, v4
    v_xor_b32 v27, 64, v26
    v_add_u32 v28, s64, v26
    v_add_u32_e64 v29, s64, v27
    v_bfe_u32 v4, v1, 2, 2
    v_and_b32_e64 v7, 3, v1
    v_cmp_eq_u32 s[88:89], 1, v7
    v_cmp_eq_u32 s[90:91], 2, v7
    v_cmp_eq_u32 s[92:93], 3, v7
    v_cmp_eq_u32 s[94:95], v4, v3
    v_lshlrev_b32 v7, 3, v7
    v_and_b32 v5, 1, v3
    v_lshl_add_u32 v5, v5, 2, v4
    s_lshl_b32 s48, s44, 1
    v_xor_b32 v5, s48, v5
    v_lshl_add_u32 v5, v5, 5, v7
    v_lshl_add_u32 v5, v4, 8, v5
    v_lshl_add_u32 v5, v3, 12, v5
    v_add_u32 v30, 65536, v5
    v_xor_b32_e64 v31, 32, v30
    v_add_u32 v32, 65536, v30
    v_add_u32 v33, 65536, v31
    v_mov_b32 v4, 0x3f803f80
    v_accvgpr_write_b32 a168, v4
    v_accvgpr_write_b32 a169, v4
    v_accvgpr_write_b32 a170, v4
    v_accvgpr_write_b32 a171, v4
    s_and_b32 s6, s2, 3
    s_lshl_b32 s6, s6, 3
    s_bfe_u32 s48, s2, 196611
    s_add_u32 s6, s6, s48
    s_lshr_b32 s7, s2, 6
    s_xor_b32 s7, s7, 2
    s_and_b32 s48, s2, 4
    s_add_u32 s7, s7, s48
    s_add_u32 s7, s7, 2
    s_and_b32 s7, s7, 7
    s_lshr_b32 s48, s2, 3
    s_xor_b32 s48, s48, s2
    s_bfe_u32 s49, s48, 65540
    s_bfe_u32 s48, s48, 65538
    s_lshl_b32 s49, s49, 1
    s_add_u32 s80, s48, s49
    s_lshl_b32 s50, s48, 11
    v_add_u32 v48, s50, v28
    v_add_u32 v49, s50, v29
    s_lshl_b32 s48, s48, 5
    s_lshl_b32 s49, s49, 10
    v_xor_b32 v50, s48, v30
    v_add_u32 v50, s49, v50
    s_lshr_b32 s48, s6, 1
    s_sub_u32 s49, 32, s48
    s_cmp_eq_u32 s48, 0
    s_cselect_b32 s49, 16, s49
    s_bitcmp1_b32 s6, 0
    s_cselect_b32 s47, s49, s48
    s_sub_u32 s49, 64, s47
    s_cmp_eq_u32 s47, 0
    s_cselect_b32 s49, 32, s49
    s_bitcmp1_b32 s44, 1
    s_cselect_b32 s50, s49, s47
    s_cselect_b32 s58, -1.0, 1.0
    s_cmp_eq_u32 s47, 0
    s_cselect_b32 s58, 0, s58
    s_cmp_eq_u32 s50, 32
    s_cselect_b32 s57, 0, 1.0
    s_cselect_b32 s59, 1.0, 0
    s_cmp_ge_u32 s7, 4
    s_cselect_b32 s56, 0, 0x80008000
    v_lshl_add_u32 v7, v2, 6, s50
    v_cvt_f32_u32 v5, v7
    v_cvt_f32_u32 v4, v3
    v_mul_f32 v5, 0x3a000000, v5
    v_cmp_eq_u32 vcc, 0, v3
    s_lshl_b32 s49, s7, 1
    s_and_b32 s48, s44, 1
    s_add_u32 s49, s49, s48
    s_lshl_b32 s49, s49, 6
    v_lshl_add_u32 v7, v7, 10, s49
    v_and_b32 v6, 1, v3
    v_lshl_add_u32 v7, v6, 5, v7
    v_mul_u32_u24 v9, 0x8000, v6
    v_lshl_or_b32 v9, v9, 16, v9
    v_lshrrev_b32_e64 v6, 1, v3
    v_lshl_add_u32 v13, v6, 4, v7
    v_mov_b32 v7, 0x41800000
    v_add_f32 v6, 0x0, v4
    v_mul_f32 v6, v6, v5
    v_cos_f32 v144, v6
    v_sin_f32 v145, v6
    v_mul_f32 v146, s57, v144
    v_mul_f32 v147, s59, v144
    v_fmac_f32 v147, s58, v145
    v_mul_f32 v148, s57, v145
    v_mul_f32_e64 v149, s59, v145
    v_fma_f32 v149, -v144, s58, v149
    v_cvt_pk_bf16_f32 v146, v146, v147
    v_cvt_pk_bf16_f32 v148, v148, v149
    v_accvgpr_write_b32 a240, v146
    v_xor_b32 v148, s56, v148
    v_xor_b32 v146, v9, v146
    v_accvgpr_write_b32 a241, v148
    v_xor_b32_e64 v148, v9, v148
    v_accvgpr_write_b32 a224, v146
    v_accvgpr_write_b32 a225, v148
    v_sub_f32 v6, 0x42000000, v4
    v_cndmask_b32 v6, v6, v7, vcc
    v_mul_f32 v6, v6, v5
    v_cos_f32 v144, v6
    v_sin_f32 v145, v6
    v_mul_f32 v146, s57, v144
    v_mul_f32 v147, s59, v144
    v_fmac_f32 v147, s58, v145
    v_mul_f32 v148, s57, v145
    v_mul_f32_e64 v149, s59, v145
    v_fma_f32 v149, -v144, s58, v149
    v_cvt_pk_bf16_f32 v146, v146, v147
    v_cvt_pk_bf16_f32 v148, v148, v149
    v_accvgpr_write_b32 a242, v146
    v_xor_b32 v148, s56, v148
    v_xor_b32 v146, v9, v146
    v_accvgpr_write_b32 a243, v148
    v_xor_b32_e64 v148, v9, v148
    v_accvgpr_write_b32 a226, v146
    v_accvgpr_write_b32 a227, v148
    v_add_f32 v6, 0x40800000, v4
    v_mul_f32 v6, v6, v5
    v_cos_f32 v144, v6
    v_sin_f32 v145, v6
    v_mul_f32 v146, s57, v144
    v_mul_f32 v147, s59, v144
    v_fmac_f32 v147, s58, v145
    v_mul_f32 v148, s57, v145
    v_mul_f32_e64 v149, s59, v145
    v_fma_f32 v149, -v144, s58, v149
    v_cvt_pk_bf16_f32 v146, v146, v147
    v_cvt_pk_bf16_f32 v148, v148, v149
    v_accvgpr_write_b32 a244, v146
    v_xor_b32 v148, s56, v148
    v_xor_b32 v146, v9, v146
    v_accvgpr_write_b32 a245, v148
    v_xor_b32_e64 v148, v9, v148
    v_accvgpr_write_b32 a228, v146
    v_accvgpr_write_b32 a229, v148
    v_sub_f32 v6, 0x41e00000, v4
    v_mul_f32 v6, v6, v5
    v_cos_f32 v144, v6
    v_sin_f32 v145, v6
    v_mul_f32 v146, s57, v144
    v_mul_f32 v147, s59, v144
    v_fmac_f32 v147, s58, v145
    v_mul_f32 v148, s57, v145
    v_mul_f32 v149, s59, v145
    v_fma_f32 v149, -v144, s58, v149
    v_cvt_pk_bf16_f32 v146, v146, v147
    v_cvt_pk_bf16_f32 v148, v148, v149
    v_accvgpr_write_b32 a246, v146
    v_xor_b32 v148, s56, v148
    v_xor_b32 v146, v9, v146
    v_accvgpr_write_b32 a247, v148
    v_xor_b32_e64 v148, v9, v148
    v_accvgpr_write_b32 a230, v146
    v_accvgpr_write_b32 a231, v148
    v_add_f32 v6, 0x41000000, v4
    v_mul_f32 v6, v6, v5
    v_cos_f32 v144, v6
    v_sin_f32 v145, v6
    v_mul_f32 v146, s57, v144
    v_mul_f32 v147, s59, v144
    v_fmac_f32 v147, s58, v145
    v_mul_f32 v148, s57, v145
    v_mul_f32 v149, s59, v145
    v_fma_f32 v149, -v144, s58, v149
    v_cvt_pk_bf16_f32 v146, v146, v147
    v_cvt_pk_bf16_f32 v148, v148, v149
    v_accvgpr_write_b32 a248, v146
    v_xor_b32 v148, s56, v148
    v_xor_b32 v146, v9, v146
    v_accvgpr_write_b32 a249, v148
    v_xor_b32_e64 v148, v9, v148
    v_accvgpr_write_b32 a232, v146
    v_accvgpr_write_b32 a233, v148
    v_sub_f32 v6, 0x41c00000, v4
    v_mul_f32 v6, v6, v5
    v_cos_f32 v144, v6
    v_sin_f32 v145, v6
    v_mul_f32 v146, s57, v144
    v_mul_f32 v147, s59, v144
    v_fmac_f32 v147, s58, v145
    v_mul_f32 v148, s57, v145
    v_mul_f32 v149, s59, v145
    v_fma_f32 v149, -v144, s58, v149
    v_cvt_pk_bf16_f32 v146, v146, v147
    v_cvt_pk_bf16_f32 v148, v148, v149
    v_accvgpr_write_b32 a250, v146
    v_xor_b32 v148, s56, v148
    v_xor_b32 v146, v9, v146
    v_accvgpr_write_b32 a251, v148
    v_xor_b32_e64 v148, v9, v148
    v_accvgpr_write_b32 a234, v146
    v_accvgpr_write_b32 a235, v148
    v_add_f32 v6, 0x41400000, v4
    v_mul_f32 v6, v6, v5
    v_cos_f32 v144, v6
    v_sin_f32 v145, v6
    v_mul_f32 v146, s57, v144
    v_mul_f32 v147, s59, v144
    v_fmac_f32 v147, s58, v145
    v_mul_f32 v148, s57, v145
    v_mul_f32 v149, s59, v145
    v_fma_f32 v149, -v144, s58, v149
    v_cvt_pk_bf16_f32 v146, v146, v147
    v_cvt_pk_bf16_f32 v148, v148, v149
    v_accvgpr_write_b32 a252, v146
    v_xor_b32 v148, s56, v148
    v_xor_b32 v146, v9, v146
    v_accvgpr_write_b32 a253, v148
    v_xor_b32_e64 v148, v9, v148
    v_accvgpr_write_b32 a236, v146
    v_accvgpr_write_b32 a237, v148
    v_sub_f32 v6, 0x41a00000, v4
    v_mul_f32 v6, v6, v5
    v_cos_f32 v144, v6
    v_sin_f32 v145, v6
    v_mul_f32 v146, s57, v144
    v_mul_f32 v147, s59, v144
    v_fmac_f32 v147, s58, v145
    v_mul_f32 v148, s57, v145
    v_mul_f32 v149, s59, v145
    v_fma_f32 v149, -v144, s58, v149
    v_cvt_pk_bf16_f32 v146, v146, v147
    v_cvt_pk_bf16_f32 v148, v148, v149
    v_accvgpr_write_b32 a254, v146
    v_xor_b32 v148, s56, v148
    v_xor_b32 v146, v9, v146
    v_accvgpr_write_b32 a255, v148
    v_xor_b32_e64 v148, v9, v148
    v_accvgpr_write_b32 a238, v146
    v_accvgpr_write_b32 a239, v148
    buffer_load_dwordx4 v20, s[28:31], s66 offen offset:2048 lds
    buffer_load_dwordx4 v21, s[28:31], s66 offen offset:3072 lds
    s_add_u32 m0, s64, 16384
    s_xor_b32 s65, s65, 512
    buffer_load_dwordx4 v16, s[20:23], s65 offen offset:0 lds
    s_add_u32 s68, s68, 1
    s_and_b32 s68, s68, 3
    s_or_b32 s68, s68, 4
    buffer_load_dwordx4 v17, s[20:23], s65 offen offset:1024 lds
    buffer_load_dwordx4 v18, s[20:23], s65 offen offset:2048 lds
    buffer_load_dwordx4 v19, s[20:23], s65 offen offset:3072 lds
    s_cmp_ge_u32 s46, 14
    s_cbranch_scc1 L_dft
    s_waitcnt vmcnt(9)
    s_barrier
    ds_read_b64_tr_b16 a[96:97], v30 offset:0
    ds_read_b64_tr_b16 a[98:99], v30 offset:1024
    ds_read_b128 a[172:175], v26 offset:0
    ds_read_b64_tr_b16 a[100:101], v31 offset:0
    ds_read_b64_tr_b16 a[102:103], v31 offset:1024
    ds_read_b64_tr_b16 a[104:105], v30 offset:2048
    ds_read_b64_tr_b16 a[106:107], v30 offset:3072
    ds_read_b64_tr_b16 a[108:109], v31 offset:2048
    ds_read_b64_tr_b16 a[110:111], v31 offset:3072
    ds_read_b128 a[176:179], v26 offset:2048
    ds_read_b128 a[180:183], v26 offset:4096
    ds_read_b128 a[184:187], v26 offset:6144
    ds_read_b128 a[160:163], v48 offset:0
    ds_read_b64_tr_b16 a[164:165], v50 offset:0
    ds_read_b64_tr_b16 a[166:167], v50 offset:1024
    s_waitcnt lgkmcnt(12)
    v_mfma_f32_16x16x32_bf16 v[128:131], a[96:99], a[172:175], 0
    ds_read_b128 a[188:191], v26 offset:8192
    s_waitcnt lgkmcnt(11)
    v_mfma_f32_16x16x32_bf16 v[132:135], a[100:103], a[172:175], 0
    s_add_u32 m0, s64, 98304
    s_add_u32 s66, s66, s0
    s_waitcnt lgkmcnt(9)
    v_mfma_f32_16x16x32_bf16 v[136:139], a[104:107], a[172:175], 0
    buffer_load_dwordx4 v20, s[24:27], s66 offen offset:0 lds
    s_waitcnt lgkmcnt(7)
    v_mfma_f32_16x16x32_bf16 v[140:143], a[108:111], a[172:175], 0
    s_waitcnt lgkmcnt(6)
    v_mfma_f32_16x16x32_bf16 v[156:159], a[108:111], a[176:179], 0
    ds_read_b128 a[192:195], v26 offset:10240
    v_mfma_f32_16x16x32_bf16 v[152:155], a[104:107], a[176:179], 0
    v_mfma_f32_16x16x32_bf16 v[148:151], a[100:103], a[176:179], 0
    buffer_load_dwordx4 v21, s[24:27], s66 offen offset:1024 lds
    v_mfma_f32_16x16x32_bf16 v[144:147], a[96:99], a[176:179], 0
    s_waitcnt lgkmcnt(6)
    v_mfma_f32_16x16x32_bf16 v[160:163], a[96:99], a[180:183], 0
    ds_read_b128 a[172:175], v26 offset:12288
    v_mfma_f32_16x16x32_bf16 v[164:167], a[100:103], a[180:183], 0
    v_mfma_f32_16x16x32_bf16 v[168:171], a[104:107], a[180:183], 0
    buffer_load_dwordx4 v20, s[28:31], s66 offen offset:2048 lds
    v_mfma_f32_16x16x32_bf16 v[172:175], a[108:111], a[180:183], 0
    s_waitcnt lgkmcnt(5)
    v_mfma_f32_16x16x32_bf16 v[120:123], a[160:163], a[160:163], 0
    v_mfma_f32_16x16x32_bf16 v[96:99], a[168:171], a[160:163], 0
    s_waitcnt lgkmcnt(3)
    v_mfma_f32_16x16x32_bf16 v[104:107], a[168:171], a[164:167], 0
    s_lshl_b32 s50, s80, 10
    s_lshl_b32 s49, s44, 1
    s_and_b32 s49, s49, 2
    s_xor_b32 s49, s49, s44
    s_cmp_eq_u32 s45, 0
    s_cselect_b32 s48, s44, s49
    s_cmp_ge_u32 s46, 14
    s_cselect_b32 s48, s48, s44
    s_lshl_b32 s71, s45, 2
    s_add_u32 s71, s71, s48
    s_lshl_b32 s71, s71, 12
    s_and_b32 s49, s50, 2048
    s_add_u32 s71, s71, s49
    s_add_u32 s71, s71, 10551296
    s_lshl_b32 s81, s46, 14
    s_add_u32 s81, s81, s64
    s_add_u32 s81, s81, 10813440
    s_add_u32 s48, s46, 16
    s_bitcmp1_b32 s44, 0
    s_cselect_b32 s48, s48, s45
    s_cselect_b32 s49, 0, 2
    s_cselect_b32 s53, 16, 8
    s_and_b32 s49, s49, s80
    s_lshr_b32 s50, s44, 1
    s_add_u32 s49, s49, s50
    s_lshl_b32 s48, s48, 2
    s_add_u32 s48, s48, s49
    s_lshl_b32 s48, s48, 7
    s_add_u32 s56, s48, 10502144
    s_and_b32 s8, s6, 3
    s_mul_i32 s8, s8, 7
    s_add_u32 s8, s8, 2
    s_lshr_b32 s8, s8, 2
    s_lshl_b32 s8, s8, 11
    s_add_u32 s9, s8, 2048
    s_cmp_eq_u32 s9, 14336
    s_cselect_b32 s9, 0, s9
    s_add_u32 s10, s9, 2048
    s_cmp_eq_u32 s10, 14336
    s_cselect_b32 s10, 0, s10
    s_add_u32 s11, s10, 2048
    s_cmp_eq_u32 s11, 14336
    s_cselect_b32 s11, 0, s11
    s_add_u32 s12, s11, 2048
    s_cmp_eq_u32 s12, 14336
    s_cselect_b32 s12, 0, s12
    s_add_u32 s13, s12, 2048
    s_cmp_eq_u32 s13, 14336
    s_cselect_b32 s13, 0, s13
    s_add_u32 s14, s13, 2048
    s_cmp_eq_u32 s14, 14336
    s_cselect_b32 s14, 0, s14
    s_cmp_eq_u32 s8, 8192
    s_cselect_b32 s48, 2048, 0
    s_add_u32 s9, s9, s48
    s_sub_u32 s10, s10, s48
    s_waitcnt vmcnt(7)
    s_barrier
    s_and_b32 s48, s2, 199
    s_or_b32 s48, s48, s44
    s_cbranch_scc0 Lgz_rare
Lgz_done:
    v_mfma_f32_16x16x32_bf16 v[188:191], a[108:111], a[184:187], 0
    ds_read_b128 a[176:179], v26 offset:14336
    ds_read_b64_tr_b16 a[112:113], v30 offset:16384
    v_mfma_f32_16x16x32_bf16 v[184:187], a[104:107], a[184:187], 0
    ds_read_b64_tr_b16 a[114:115], v30 offset:17408
    ds_read_b64_tr_b16 a[116:117], v31 offset:16384
    v_mfma_f32_16x16x32_bf16 v[180:183], a[100:103], a[184:187], 0
    buffer_load_dwordx4 v21, s[28:31], s66 offen offset:3072 lds
    v_mfma_f32_16x16x32_bf16 v[176:179], a[96:99], a[184:187], 0
    ds_read_b64_tr_b16 a[118:119], v31 offset:17408
    s_waitcnt lgkmcnt(7)
    v_mfma_f32_16x16x32_bf16 v[192:195], a[96:99], a[188:191], 0
    ds_read_b128 a[180:183], v27 offset:0
    ds_read_b64_tr_b16 a[120:121], v30 offset:18432
    v_mfma_f32_16x16x32_bf16 v[196:199], a[100:103], a[188:191], 0
    s_add_u32 m0, s64, 114688
    s_add_u32 s66, s66, s67
    v_mfma_f32_16x16x32_bf16 v[200:203], a[104:107], a[188:191], 0
    buffer_load_dwordx4 v20, s[24:27], s66 offen offset:0 lds
    v_mfma_f32_16x16x32_bf16 v[204:207], a[108:111], a[188:191], 0
    ds_read_b64_tr_b16 a[122:123], v30 offset:19456
    s_waitcnt lgkmcnt(9)
    v_mfma_f32_16x16x32_bf16 v[220:223], a[108:111], a[192:195], 0
    ds_read_b128 a[184:187], v27 offset:2048
    ds_read_b64_tr_b16 a[124:125], v31 offset:18432
    v_mfma_f32_16x16x32_bf16 v[216:219], a[104:107], a[192:195], 0
    ds_read_b64_tr_b16 a[126:127], v31 offset:19456
    ds_read_b128 a[160:163], v49 offset:0
    v_mfma_f32_16x16x32_bf16 v[212:215], a[100:103], a[192:195], 0
    buffer_load_dwordx4 v21, s[24:27], s66 offen offset:1024 lds
    v_mfma_f32_16x16x32_bf16 v[208:211], a[96:99], a[192:195], 0
    ds_read_b64_tr_b16 a[164:165], v50 offset:16384
    s_waitcnt lgkmcnt(13)
    v_mfma_f32_16x16x32_bf16 v[224:227], a[96:99], a[172:175], 0
    ds_read_b128 a[188:191], v27 offset:4096
    ds_read_b64_tr_b16 a[166:167], v50 offset:17408
    v_mfma_f32_16x16x32_bf16 v[228:231], a[100:103], a[172:175], 0
    v_mfma_f32_16x16x32_bf16 v[232:235], a[104:107], a[172:175], 0
    buffer_load_dwordx4 v20, s[28:31], s66 offen offset:2048 lds
    v_mfma_f32_16x16x32_bf16 v[236:239], a[108:111], a[172:175], 0
    s_waitcnt lgkmcnt(14)
    v_mfma_f32_16x16x32_bf16 v[252:255], a[108:111], a[176:179], 0
    ds_read_b128 a[192:195], v27 offset:6144
    v_mfma_f32_16x16x32_bf16 v[248:251], a[104:107], a[176:179], 0
    v_mfma_f32_16x16x32_bf16 v[244:247], a[100:103], a[176:179], 0
    buffer_load_dwordx4 v21, s[28:31], s66 offen offset:3072 lds
    v_mfma_f32_16x16x32_bf16 v[240:243], a[96:99], a[176:179], 0
    s_waitcnt lgkmcnt(10)
    v_mfma_f32_16x16x32_bf16 v[128:131], a[112:115], a[180:183], v[128:131]
    ds_read_b128 a[172:175], v27 offset:8192
    v_mfma_f32_16x16x32_bf16 v[132:135], a[116:119], a[180:183], v[132:135]
    s_add_u32 m0, s64, 32768
    s_lshl_b32 s65, s68, 7
    s_waitcnt lgkmcnt(9)
    v_mfma_f32_16x16x32_bf16 v[136:139], a[120:123], a[180:183], v[136:139]
    buffer_load_dwordx4 v16, s[20:23], s65 offen offset:0 lds
    s_waitcnt lgkmcnt(6)
    v_mfma_f32_16x16x32_bf16 v[140:143], a[124:127], a[180:183], v[140:143]
    v_mfma_f32_16x16x32_bf16 v[156:159], a[124:127], a[184:187], v[156:159]
    ds_read_b128 a[176:179], v27 offset:10240
    v_mfma_f32_16x16x32_bf16 v[152:155], a[120:123], a[184:187], v[152:155]
    v_mfma_f32_16x16x32_bf16 v[148:151], a[116:119], a[184:187], v[148:151]
    buffer_load_dwordx4 v17, s[20:23], s65 offen offset:1024 lds
    v_mfma_f32_16x16x32_bf16 v[144:147], a[112:115], a[184:187], v[144:147]
    s_waitcnt lgkmcnt(4)
    v_mfma_f32_16x16x32_bf16 v[160:163], a[112:115], a[188:191], v[160:163]
    ds_read_b128 a[180:183], v27 offset:12288
    v_mfma_f32_16x16x32_bf16 v[164:167], a[116:119], a[188:191], v[164:167]
    v_mfma_f32_16x16x32_bf16 v[168:171], a[120:123], a[188:191], v[168:171]
    buffer_load_dwordx4 v18, s[20:23], s65 offen offset:2048 lds
    v_mfma_f32_16x16x32_bf16 v[172:175], a[124:127], a[188:191], v[172:175]
    v_mfma_f32_16x16x32_bf16 v[120:123], a[160:163], a[160:163], v[120:123]
    v_mfma_f32_16x16x32_bf16 v[96:99], a[168:171], a[160:163], v[96:99]
    s_waitcnt lgkmcnt(4)
    v_mfma_f32_16x16x32_bf16 v[104:107], a[168:171], a[164:167], v[104:107]
    s_mov_b32 s1, 0
    s_mov_b64 exec, 0
    s_cmp_eq_u32 s44, 0
    s_cbranch_scc1 Lpad_g0
    s_cmp_eq_u32 s44, 1
    s_cbranch_scc1 Lpad_g1
    s_cmp_eq_u32 s44, 2
    s_cbranch_scc1 Lpad_g2
    s_branch Lpad_s0
Ltramp:
    s_cmp_eq_u32 s1, 1
    s_cbranch_scc1 Lret_d
Lret_g:
    s_mov_b64 exec, -1
    s_waitcnt vmcnt(7)
    s_barrier
    s_waitcnt lgkmcnt(3)
    v_mfma_f32_16x16x32_bf16 v[188:191], a[124:127], a[192:195], v[188:191]
    ds_read_b128 a[184:187], v27 offset:14336
    ds_read_b64_tr_b16 a[128:129], v30 offset:32768
    v_mfma_f32_16x16x32_bf16 v[184:187], a[120:123], a[192:195], v[184:187]
    ds_read_b64_tr_b16 a[130:131], v30 offset:33792
    ds_read_b64_tr_b16 a[132:133], v31 offset:32768
    v_mfma_f32_16x16x32_bf16 v[180:183], a[116:119], a[192:195], v[180:183]
    buffer_load_dwordx4 v19, s[20:23], s65 offen offset:3072 lds
    v_mfma_f32_16x16x32_bf16 v[176:179], a[112:115], a[192:195], v[176:179]
    ds_read_b64_tr_b16 a[134:135], v31 offset:33792
    s_waitcnt lgkmcnt(7)
    v_mfma_f32_16x16x32_bf16 v[192:195], a[112:115], a[172:175], v[192:195]
    ds_read_b128 a[188:191], v26 offset:16384
    ds_read_b64_tr_b16 a[136:137], v30 offset:34816
    v_mfma_f32_16x16x32_bf16 v[196:199], a[116:119], a[172:175], v[196:199]
    s_add_u32 m0, s64, 131072
    s_mul_i32 s66, s69, s15
    v_mfma_f32_16x16x32_bf16 v[200:203], a[120:123], a[172:175], v[200:203]
    buffer_load_dwordx4 v20, s[24:27], s66 offen offset:0 lds
    v_mfma_f32_16x16x32_bf16 v[204:207], a[124:127], a[172:175], v[204:207]
    ds_read_b64_tr_b16 a[138:139], v30 offset:35840
    s_waitcnt lgkmcnt(9)
    v_mfma_f32_16x16x32_bf16 v[220:223], a[124:127], a[176:179], v[220:223]
    ds_read_b128 a[192:195], v26 offset:18432
    ds_read_b64_tr_b16 a[140:141], v31 offset:34816
    v_mfma_f32_16x16x32_bf16 v[216:219], a[120:123], a[176:179], v[216:219]
    ds_read_b64_tr_b16 a[142:143], v31 offset:35840
    ds_read_b128 a[160:163], v48 offset:16384
    v_mfma_f32_16x16x32_bf16 v[212:215], a[116:119], a[176:179], v[212:215]
    buffer_load_dwordx4 v21, s[24:27], s66 offen offset:1024 lds
    v_mfma_f32_16x16x32_bf16 v[208:211], a[112:115], a[176:179], v[208:211]
    ds_read_b64_tr_b16 a[164:165], v50 offset:32768
    s_waitcnt lgkmcnt(13)
    v_mfma_f32_16x16x32_bf16 v[224:227], a[112:115], a[180:183], v[224:227]
    ds_read_b128 a[172:175], v26 offset:20480
    ds_read_b64_tr_b16 a[166:167], v50 offset:33792
    v_mfma_f32_16x16x32_bf16 v[228:231], a[116:119], a[180:183], v[228:231]
    v_mfma_f32_16x16x32_bf16 v[232:235], a[120:123], a[180:183], v[232:235]
    buffer_load_dwordx4 v20, s[28:31], s66 offen offset:2048 lds
    v_mfma_f32_16x16x32_bf16 v[236:239], a[124:127], a[180:183], v[236:239]
    s_waitcnt lgkmcnt(14)
    v_mfma_f32_16x16x32_bf16 v[252:255], a[124:127], a[184:187], v[252:255]
    ds_read_b128 a[176:179], v26 offset:22528
    v_mfma_f32_16x16x32_bf16 v[248:251], a[120:123], a[184:187], v[248:251]
    v_mfma_f32_16x16x32_bf16 v[244:247], a[116:119], a[184:187], v[244:247]
    buffer_load_dwordx4 v21, s[28:31], s66 offen offset:3072 lds
    v_mfma_f32_16x16x32_bf16 v[240:243], a[112:115], a[184:187], v[240:243]
    s_waitcnt lgkmcnt(10)
    v_mfma_f32_16x16x32_bf16 v[128:131], a[128:131], a[188:191], v[128:131]
    ds_read_b128 a[180:183], v26 offset:24576
    v_mfma_f32_16x16x32_bf16 v[132:135], a[132:135], a[188:191], v[132:135]
    s_waitcnt lgkmcnt(9)
    v_mfma_f32_16x16x32_bf16 v[136:139], a[136:139], a[188:191], v[136:139]
    s_waitcnt lgkmcnt(6)
    v_mfma_f32_16x16x32_bf16 v[140:143], a[140:143], a[188:191], v[140:143]
    v_mfma_f32_16x16x32_bf16 v[156:159], a[140:143], a[192:195], v[156:159]
    ds_read_b128 a[184:187], v26 offset:26624
    v_mfma_f32_16x16x32_bf16 v[152:155], a[136:139], a[192:195], v[152:155]
    v_mfma_f32_16x16x32_bf16 v[148:151], a[132:135], a[192:195], v[148:151]
    v_mfma_f32_16x16x32_bf16 v[144:147], a[128:131], a[192:195], v[144:147]
    s_waitcnt lgkmcnt(4)
    v_mfma_f32_16x16x32_bf16 v[160:163], a[128:131], a[172:175], v[160:163]
    ds_read_b128 a[188:191], v26 offset:28672
    v_mfma_f32_16x16x32_bf16 v[164:167], a[132:135], a[172:175], v[164:167]
    v_mfma_f32_16x16x32_bf16 v[168:171], a[136:139], a[172:175], v[168:171]
    v_mfma_f32_16x16x32_bf16 v[172:175], a[140:143], a[172:175], v[172:175]
    v_mfma_f32_16x16x32_bf16 v[120:123], a[160:163], a[160:163], v[120:123]
    v_mfma_f32_16x16x32_bf16 v[96:99], a[168:171], a[160:163], v[96:99]
    s_waitcnt lgkmcnt(4)
    v_mfma_f32_16x16x32_bf16 v[104:107], a[168:171], a[164:167], v[104:107]
    s_waitcnt vmcnt(8)
    s_barrier
    s_waitcnt lgkmcnt(3)
    v_mfma_f32_16x16x32_bf16 v[188:191], a[140:143], a[176:179], v[188:191]
    ds_read_b128 a[192:195], v26 offset:30720
    ds_read_b64_tr_b16 a[144:145], v30 offset:49152
    v_mfma_f32_16x16x32_bf16 v[184:187], a[136:139], a[176:179], v[184:187]
    s_add_u32 m0, s64, 147456
    s_add_u32 s66, s66, s67
    v_mfma_f32_16x16x32_bf16 v[180:183], a[132:135], a[176:179], v[180:183]
    buffer_load_dwordx4 v20, s[24:27], s66 offen offset:0 lds
    v_mfma_f32_16x16x32_bf16 v[176:179], a[128:131], a[176:179], v[176:179]
    ds_read_b64_tr_b16 a[146:147], v30 offset:50176
    s_waitcnt lgkmcnt(5)
    v_mfma_f32_16x16x32_bf16 v[192:195], a[128:131], a[180:183], v[192:195]
    ds_read_b128 a[172:175], v27 offset:16384
    ds_read_b64_tr_b16 a[148:149], v31 offset:49152
    v_mfma_f32_16x16x32_bf16 v[196:199], a[132:135], a[180:183], v[196:199]
    s_add_u32 s69, s69, 1
    s_and_b32 s69, s69, 3
    s_or_b32 s69, s69, 4
    v_mfma_f32_16x16x32_bf16 v[200:203], a[136:139], a[180:183], v[200:203]
    buffer_load_dwordx4 v21, s[24:27], s66 offen offset:1024 lds
    v_mfma_f32_16x16x32_bf16 v[204:207], a[140:143], a[180:183], v[204:207]
    ds_read_b64_tr_b16 a[150:151], v31 offset:50176
    s_waitcnt lgkmcnt(7)
    v_mfma_f32_16x16x32_bf16 v[220:223], a[140:143], a[184:187], v[220:223]
    ds_read_b128 a[176:179], v27 offset:18432
    ds_read_b64_tr_b16 a[152:153], v30 offset:51200
    v_mfma_f32_16x16x32_bf16 v[216:219], a[136:139], a[184:187], v[216:219]
    ds_read_b64_tr_b16 a[154:155], v30 offset:52224
    ds_read_b64_tr_b16 a[156:157], v31 offset:51200
    v_mfma_f32_16x16x32_bf16 v[212:215], a[132:135], a[184:187], v[212:215]
    buffer_load_dwordx4 v20, s[28:31], s66 offen offset:2048 lds
    v_mfma_f32_16x16x32_bf16 v[208:211], a[128:131], a[184:187], v[208:211]
    ds_read_b64_tr_b16 a[158:159], v31 offset:52224
    s_waitcnt lgkmcnt(11)
    v_mfma_f32_16x16x32_bf16 v[224:227], a[128:131], a[188:191], v[224:227]
    ds_read_b128 a[180:183], v27 offset:20480
    ds_read_b128 a[160:163], v49 offset:16384
    v_mfma_f32_16x16x32_bf16 v[228:231], a[132:135], a[188:191], v[228:231]
    ds_read_b64_tr_b16 a[164:165], v50 offset:49152
    ds_read_b64_tr_b16 a[166:167], v50 offset:50176
    v_mfma_f32_16x16x32_bf16 v[232:235], a[136:139], a[188:191], v[232:235]
    buffer_load_dwordx4 v21, s[28:31], s66 offen offset:3072 lds
    v_mfma_f32_16x16x32_bf16 v[236:239], a[140:143], a[188:191], v[236:239]
    s_waitcnt lgkmcnt(14)
    v_mfma_f32_16x16x32_bf16 v[252:255], a[140:143], a[192:195], v[252:255]
    ds_read_b128 a[184:187], v27 offset:22528
    v_mfma_f32_16x16x32_bf16 v[248:251], a[136:139], a[192:195], v[248:251]
    s_add_u32 m0, s64, 65536
    s_add_u32 s66, s66, s0
    v_mfma_f32_16x16x32_bf16 v[244:247], a[132:135], a[192:195], v[244:247]
    buffer_load_dwordx4 v20, s[24:27], s66 offen offset:0 lds
    v_mfma_f32_16x16x32_bf16 v[240:243], a[128:131], a[192:195], v[240:243]
    s_waitcnt lgkmcnt(12)
    v_mfma_f32_16x16x32_bf16 v[128:131], a[144:147], a[172:175], v[128:131]
    ds_read_b128 a[188:191], v27 offset:24576
    s_waitcnt lgkmcnt(11)
    v_mfma_f32_16x16x32_bf16 v[132:135], a[148:151], a[172:175], v[132:135]
    s_waitcnt lgkmcnt(8)
    v_mfma_f32_16x16x32_bf16 v[136:139], a[152:155], a[172:175], v[136:139]
    buffer_load_dwordx4 v21, s[24:27], s66 offen offset:1024 lds
    s_waitcnt lgkmcnt(6)
    v_mfma_f32_16x16x32_bf16 v[140:143], a[156:159], a[172:175], v[140:143]
    s_waitcnt lgkmcnt(4)
    v_mfma_f32_16x16x32_bf16 v[120:123], a[160:163], a[160:163], v[120:123]
    v_mfma_f32_16x16x32_bf16 v[96:99], a[168:171], a[160:163], v[96:99]
    s_waitcnt lgkmcnt(2)
    v_mfma_f32_16x16x32_bf16 v[104:107], a[168:171], a[164:167], v[104:107]
    s_waitcnt vmcnt(2)
    s_barrier
    v_mfma_f32_16x16x32_bf16 v[156:159], a[156:159], a[176:179], v[156:159]
    ds_read_b128 a[192:195], v27 offset:26624
    ds_read_b64_tr_b16 a[96:97], v32 offset:0
    v_mfma_f32_16x16x32_bf16 v[152:155], a[152:155], a[176:179], v[152:155]
    ds_read_b64_tr_b16 a[98:99], v32 offset:1024
    ds_read_b64_tr_b16 a[100:101], v33 offset:0
    v_mfma_f32_16x16x32_bf16 v[148:151], a[148:151], a[176:179], v[148:151]
    buffer_load_dwordx4 v20, s[28:31], s66 offen offset:2048 lds
    v_mfma_f32_16x16x32_bf16 v[144:147], a[144:147], a[176:179], v[144:147]
    ds_read_b64_tr_b16 a[102:103], v33 offset:1024
    v_mfma_f32_16x16x32_bf16 v[160:163], a[144:147], a[180:183], v[160:163]
    ds_read_b128 a[172:175], v27 offset:28672
    ds_read_b64_tr_b16 a[104:105], v32 offset:2048
    v_mfma_f32_16x16x32_bf16 v[164:167], a[148:151], a[180:183], v[164:167]
    ds_read_b64_tr_b16 a[106:107], v32 offset:3072
    ds_read_b64_tr_b16 a[108:109], v33 offset:2048
    v_mfma_f32_16x16x32_bf16 v[168:171], a[152:155], a[180:183], v[168:171]
    buffer_load_dwordx4 v21, s[28:31], s66 offen offset:3072 lds
    v_mfma_f32_16x16x32_bf16 v[172:175], a[156:159], a[180:183], v[172:175]
    ds_read_b64_tr_b16 a[110:111], v33 offset:3072
    s_waitcnt lgkmcnt(11)
    v_mfma_f32_16x16x32_bf16 v[188:191], a[156:159], a[184:187], v[188:191]
    ds_read_b128 a[176:179], v27 offset:30720
    ds_read_b64_tr_b16 a[112:113], v32 offset:16384
    v_mfma_f32_16x16x32_bf16 v[184:187], a[152:155], a[184:187], v[184:187]
    s_add_u32 m0, s64, 49152
    s_xor_b32 s65, s65, 512
    v_mfma_f32_16x16x32_bf16 v[180:183], a[148:151], a[184:187], v[180:183]
    buffer_load_dwordx4 v16, s[20:23], s65 offen offset:0 lds
    v_mfma_f32_16x16x32_bf16 v[176:179], a[144:147], a[184:187], v[176:179]
    ds_read_b64_tr_b16 a[114:115], v32 offset:17408
    s_waitcnt lgkmcnt(13)
    v_mfma_f32_16x16x32_bf16 v[192:195], a[144:147], a[188:191], v[192:195]
    ds_read_b128 a[180:183], v26 offset:32768
    ds_read_b64_tr_b16 a[116:117], v33 offset:16384
    v_mfma_f32_16x16x32_bf16 v[196:199], a[148:151], a[188:191], v[196:199]
    s_add_u32 s68, s68, 1
    s_and_b32 s68, s68, 3
    s_or_b32 s68, s68, 4
    v_mfma_f32_16x16x32_bf16 v[200:203], a[152:155], a[188:191], v[200:203]
    buffer_load_dwordx4 v17, s[20:23], s65 offen offset:1024 lds
    v_mfma_f32_16x16x32_bf16 v[204:207], a[156:159], a[188:191], v[204:207]
    ds_read_b64_tr_b16 a[118:119], v33 offset:17408
    s_waitcnt lgkmcnt(14)
    v_mfma_f32_16x16x32_bf16 v[220:223], a[156:159], a[192:195], v[220:223]
    ds_read_b128 a[184:187], v27 offset:32768
    ds_read_b64_tr_b16 a[120:121], v32 offset:18432
    v_mfma_f32_16x16x32_bf16 v[216:219], a[152:155], a[192:195], v[216:219]
    ds_read_b64_tr_b16 a[122:123], v32 offset:19456
    ds_read_b64_tr_b16 a[124:125], v33 offset:18432
    v_mfma_f32_16x16x32_bf16 v[212:215], a[148:151], a[192:195], v[212:215]
    buffer_load_dwordx4 v18, s[20:23], s65 offen offset:2048 lds
    v_mfma_f32_16x16x32_bf16 v[208:211], a[144:147], a[192:195], v[208:211]
    ds_read_b64_tr_b16 a[126:127], v33 offset:19456
    s_waitcnt lgkmcnt(14)
    v_mfma_f32_16x16x32_bf16 v[224:227], a[144:147], a[172:175], v[224:227]
    ds_read_b128 a[188:191], v26 offset:34816
    v_lshlrev_b32 v4, 3, v2
    v_mfma_f32_16x16x32_bf16 v[228:231], a[148:151], a[172:175], v[228:231]
    v_lshlrev_b32 v5, 2, v1
    v_cmp_gt_u32 vcc, 16, v1
    v_mfma_f32_16x16x32_bf16 v[232:235], a[152:155], a[172:175], v[232:235]
    buffer_load_dwordx4 v19, s[20:23], s65 offen offset:3072 lds
    v_mfma_f32_16x16x32_bf16 v[236:239], a[156:159], a[172:175], v[236:239]
    v_cndmask_b32 v4, v10, v4, s[94:95]
    s_waitcnt lgkmcnt(11)
    v_mfma_f32_16x16x32_bf16 v[252:255], a[156:159], a[176:179], v[252:255]
    ds_read_b128 a[192:195], v27 offset:34816
    v_cndmask_b32 v120, v120, v121, s[88:89]
    v_mfma_f32_16x16x32_bf16 v[248:251], a[152:155], a[176:179], v[248:251]
    s_add_u32 m0, s64, 81920
    s_add_u32 s66, s66, s67
    v_mfma_f32_16x16x32_bf16 v[244:247], a[148:151], a[176:179], v[244:247]
    buffer_load_dwordx4 v20, s[24:27], s66 offen offset:0 lds
    v_mfma_f32_16x16x32_bf16 v[240:243], a[144:147], a[176:179], v[240:243]
    v_cndmask_b32 v5, v10, v5, vcc
    s_waitcnt lgkmcnt(6)
    v_mfma_f32_16x16x32_bf16 v[128:131], a[96:99], a[180:183], v[128:131]
    ds_read_b128 a[172:175], v26 offset:36864
    v_cndmask_b32 v120, v120, v122, s[90:91]
    v_mfma_f32_16x16x32_bf16 v[128:131], a[112:115], a[184:187], v[128:131]
    v_cndmask_b32 v97, v120, v123, s[92:93]
    s_and_b32 s54, s80, 1
    v_mfma_f32_16x16x32_bf16 v[132:135], a[116:119], a[184:187], v[132:135]
    buffer_load_dwordx4 v21, s[24:27], s66 offen offset:1024 lds
    v_mfma_f32_16x16x32_bf16 v[132:135], a[100:103], a[180:183], v[132:135]
    s_lshl_b32 s54, s54, 4
    s_lshl3_add_u32 s54, s54, s71
    v_mfma_f32_16x16x32_bf16 v[136:139], a[104:107], a[180:183], v[136:139]
    ds_read_b128 a[176:179], v27 offset:36864
    s_add_u32 s54, s54, s70
    s_waitcnt lgkmcnt(6)
    v_mfma_f32_16x16x32_bf16 v[136:139], a[120:123], a[184:187], v[136:139]
    s_lshl_b32 s55, s80, 6
    s_add_u32 s55, s55, s70
    s_waitcnt lgkmcnt(4)
    v_mfma_f32_16x16x32_bf16 v[140:143], a[124:127], a[184:187], v[140:143]
    buffer_load_dwordx4 v20, s[28:31], s66 offen offset:2048 lds
    v_mfma_f32_16x16x32_bf16 v[140:143], a[108:111], a[180:183], v[140:143]
    s_add_u32 s55, s55, s81
    s_waitcnt lgkmcnt(2)
    v_mfma_f32_16x16x32_bf16 v[156:159], a[108:111], a[188:191], v[156:159]
    ds_read_b128 a[180:183], v26 offset:38912
    v_lshlrev_b32_e64 v15, 4, v1
    v_mfma_f32_16x16x32_bf16 v[156:159], a[124:127], a[192:195], v[156:159]
    v_mfma_f32_16x16x32_bf16 v[152:155], a[120:123], a[192:195], v[152:155]
    buffer_load_dwordx4 v21, s[28:31], s66 offen offset:3072 lds
    v_mfma_f32_16x16x32_bf16 v[152:155], a[104:107], a[188:191], v[152:155]
    s_waitcnt vmcnt(8)
    s_barrier
    v_mfma_f32_16x16x32_bf16 v[148:151], a[100:103], a[188:191], v[148:151]
    ds_read_b128 a[184:187], v27 offset:38912
    ds_read_b64_tr_b16 a[128:129], v30 offset:0
    v_mfma_f32_16x16x32_bf16 v[148:151], a[116:119], a[192:195], v[148:151]
    s_add_u32 m0, s64, 98304
    s_mul_i32 s66, s69, s15
    v_mfma_f32_16x16x32_bf16 v[144:147], a[112:115], a[192:195], v[144:147]
    buffer_load_dwordx4 v20, s[24:27], s66 offen offset:0 lds
    v_mfma_f32_16x16x32_bf16 v[144:147], a[96:99], a[188:191], v[144:147]
    ds_read_b64_tr_b16 a[130:131], v30 offset:1024
    s_waitcnt lgkmcnt(4)
    v_mfma_f32_16x16x32_bf16 v[160:163], a[96:99], a[172:175], v[160:163]
    ds_read_b128 a[188:191], v26 offset:40960
    ds_read_b64_tr_b16 a[132:133], v31 offset:0
    v_mfma_f32_16x16x32_bf16 v[160:163], a[112:115], a[176:179], v[160:163]
    ds_read_b64_tr_b16 a[134:135], v31 offset:1024
    ds_read_b64_tr_b16 a[136:137], v30 offset:2048
    v_mfma_f32_16x16x32_bf16 v[164:167], a[116:119], a[176:179], v[164:167]
    buffer_load_dwordx4 v21, s[24:27], s66 offen offset:1024 lds
    v_mfma_f32_16x16x32_bf16 v[164:167], a[100:103], a[172:175], v[164:167]
    ds_read_b64_tr_b16 a[138:139], v30 offset:3072
    ds_read_b64_tr_b16 a[140:141], v31 offset:2048
    v_mfma_f32_16x16x32_bf16 v[168:171], a[104:107], a[172:175], v[168:171]
    ds_read_b128 a[192:195], v27 offset:40960
    ds_read_b64_tr_b16 a[142:143], v31 offset:3072
    v_mfma_f32_16x16x32_bf16 v[168:171], a[120:123], a[176:179], v[168:171]
    v_mfma_f32_16x16x32_bf16 v[172:175], a[124:127], a[176:179], v[172:175]
    buffer_load_dwordx4 v20, s[28:31], s66 offen offset:2048 lds
    v_mfma_f32_16x16x32_bf16 v[172:175], a[108:111], a[172:175], v[172:175]
    s_waitcnt lgkmcnt(10)
    v_mfma_f32_16x16x32_bf16 v[188:191], a[108:111], a[180:183], v[188:191]
    ds_read_b128 a[172:175], v26 offset:43008
    v_mfma_f32_16x16x32_bf16 v[188:191], a[124:127], a[184:187], v[188:191]
    v_mfma_f32_16x16x32_bf16 v[184:187], a[120:123], a[184:187], v[184:187]
    buffer_load_dwordx4 v21, s[28:31], s66 offen offset:3072 lds
    v_mfma_f32_16x16x32_bf16 v[184:187], a[104:107], a[180:183], v[184:187]
    v_mfma_f32_16x16x32_bf16 v[180:183], a[100:103], a[180:183], v[180:183]
    ds_read_b128 a[176:179], v27 offset:43008
    v_mfma_f32_16x16x32_bf16 v[180:183], a[116:119], a[184:187], v[180:183]
    s_add_u32 m0, s64, 0
    s_lshl_b32 s65, s68, 7
    v_mfma_f32_16x16x32_bf16 v[176:179], a[112:115], a[184:187], v[176:179]
    buffer_load_dwordx4 v16, s[20:23], s65 offen offset:0 lds
    v_mfma_f32_16x16x32_bf16 v[176:179], a[96:99], a[180:183], v[176:179]
    s_load_dword s4, s[76:77], 0
    s_waitcnt lgkmcnt(3)
    v_mfma_f32_16x16x32_bf16 v[192:195], a[96:99], a[188:191], v[192:195]
    ds_read_b128 a[180:183], v26 offset:45056
    v_mfma_f32_16x16x32_bf16 v[192:195], a[112:115], a[192:195], v[192:195]
    v_mfma_f32_16x16x32_bf16 v[196:199], a[116:119], a[192:195], v[196:199]
    buffer_store_dwordx2 v[96:97], v4, s[32:35], s54 offen sc1
    v_mfma_f32_16x16x32_bf16 v[196:199], a[100:103], a[188:191], v[196:199]
    v_mfma_f32_16x16x32_bf16 v[200:203], a[104:107], a[188:191], v[200:203]
    ds_read_b128 a[184:187], v27 offset:45056
    v_mfma_f32_16x16x32_bf16 v[200:203], a[120:123], a[192:195], v[200:203]
    v_mfma_f32_16x16x32_bf16 v[204:207], a[124:127], a[192:195], v[204:207]
    buffer_store_dword v104, v5, s[32:35], s55 offen sc1
    v_mfma_f32_16x16x32_bf16 v[204:207], a[108:111], a[188:191], v[204:207]
    s_waitcnt lgkmcnt(2)
    v_mfma_f32_16x16x32_bf16 v[220:223], a[108:111], a[172:175], v[220:223]
    ds_read_b128 a[188:191], v26 offset:47104
    v_mfma_f32_16x16x32_bf16 v[220:223], a[124:127], a[176:179], v[220:223]
    v_mfma_f32_16x16x32_bf16 v[216:219], a[120:123], a[176:179], v[216:219]
    buffer_load_dwordx4 v17, s[20:23], s65 offen offset:1024 lds
    v_mfma_f32_16x16x32_bf16 v[216:219], a[104:107], a[172:175], v[216:219]
    s_waitcnt vmcnt(8)
    s_barrier
    v_mfma_f32_16x16x32_bf16 v[212:215], a[100:103], a[172:175], v[212:215]
    ds_read_b128 a[192:195], v27 offset:47104
    ds_read_b64_tr_b16 a[144:145], v30 offset:16384
    v_mfma_f32_16x16x32_bf16 v[212:215], a[116:119], a[176:179], v[212:215]
    ds_read_b64_tr_b16 a[146:147], v30 offset:17408
    ds_read_b64_tr_b16 a[148:149], v31 offset:16384
    v_mfma_f32_16x16x32_bf16 v[208:211], a[112:115], a[176:179], v[208:211]
    buffer_load_dwordx4 v18, s[20:23], s65 offen offset:2048 lds
    v_mfma_f32_16x16x32_bf16 v[208:211], a[96:99], a[172:175], v[208:211]
    ds_read_b64_tr_b16 a[150:151], v31 offset:17408
    s_waitcnt lgkmcnt(6)
    v_mfma_f32_16x16x32_bf16 v[224:227], a[96:99], a[180:183], v[224:227]
    ds_read_b128 a[172:175], v26 offset:49152
    ds_read_b64_tr_b16 a[152:153], v30 offset:18432
    v_mfma_f32_16x16x32_bf16 v[224:227], a[112:115], a[184:187], v[224:227]
    ds_read_b64_tr_b16 a[154:155], v30 offset:19456
    ds_read_b64_tr_b16 a[156:157], v31 offset:18432
    v_mfma_f32_16x16x32_bf16 v[228:231], a[116:119], a[184:187], v[228:231]
    buffer_load_dwordx4 v19, s[20:23], s65 offen offset:3072 lds
    v_mfma_f32_16x16x32_bf16 v[228:231], a[100:103], a[180:183], v[228:231]
    ds_read_b64_tr_b16 a[158:159], v31 offset:19456
    v_mfma_f32_16x16x32_bf16 v[232:235], a[104:107], a[180:183], v[232:235]
    ds_read_b128 a[176:179], v27 offset:49152
    v_mfma_f32_16x16x32_bf16 v[232:235], a[120:123], a[184:187], v[232:235]
    s_add_u32 m0, s64, 114688
    s_add_u32 s66, s66, s67
    v_mfma_f32_16x16x32_bf16 v[236:239], a[124:127], a[184:187], v[236:239]
    buffer_load_dwordx4 v20, s[24:27], s66 offen offset:0 lds
    v_mfma_f32_16x16x32_bf16 v[236:239], a[108:111], a[180:183], v[236:239]
    s_waitcnt lgkmcnt(10)
    v_mfma_f32_16x16x32_bf16 v[252:255], a[108:111], a[188:191], v[252:255]
    ds_read_b128 a[180:183], v26 offset:51200
    v_mfma_f32_16x16x32_bf16 v[252:255], a[124:127], a[192:195], v[252:255]
    s_add_u32 s69, s69, 1
    s_and_b32 s69, s69, 3
    s_or_b32 s69, s69, 4
    v_mfma_f32_16x16x32_bf16 v[248:251], a[120:123], a[192:195], v[248:251]
    buffer_load_dwordx4 v21, s[24:27], s66 offen offset:1024 lds
    v_mfma_f32_16x16x32_bf16 v[248:251], a[104:107], a[188:191], v[248:251]
    v_mfma_f32_16x16x32_bf16 v[244:247], a[100:103], a[188:191], v[244:247]
    ds_read_b128 a[184:187], v27 offset:51200
    v_mfma_f32_16x16x32_bf16 v[244:247], a[116:119], a[192:195], v[244:247]
    v_mfma_f32_16x16x32_bf16 v[240:243], a[112:115], a[192:195], v[240:243]
    buffer_load_dwordx4 v20, s[28:31], s66 offen offset:2048 lds
    v_mfma_f32_16x16x32_bf16 v[240:243], a[96:99], a[188:191], v[240:243]
    s_waitcnt lgkmcnt(2)
    v_mfma_f32_16x16x32_bf16 v[128:131], a[128:131], a[172:175], v[128:131]
    ds_read_b128 a[188:191], v26 offset:53248
    v_and_b32_e64 v35, 3, v1
    v_mfma_f32_16x16x32_bf16 v[128:131], a[144:147], a[176:179], v[128:131]
    v_bfe_u32 v34, v1, 3, 2
    v_lshl_add_u32 v34, v34, 2, v35
    v_mfma_f32_16x16x32_bf16 v[132:135], a[148:151], a[176:179], v[132:135]
    buffer_load_dwordx4 v21, s[28:31], s66 offen offset:3072 lds
    v_mfma_f32_16x16x32_bf16 v[132:135], a[132:135], a[172:175], v[132:135]
    v_lshrrev_b32_e64 v35, 2, v1
    v_lshl_add_u32 v34, v35, 4, v34
    v_mfma_f32_16x16x32_bf16 v[136:139], a[136:139], a[172:175], v[136:139]
    ds_read_b128 a[192:195], v27 offset:53248
    v_lshl_add_u32 v34, v34, 3, s64
    v_mfma_f32_16x16x32_bf16 v[136:139], a[152:155], a[176:179], v[136:139]
    s_add_u32 m0, s64, 131072
    s_add_u32 s66, s66, s0
    v_mfma_f32_16x16x32_bf16 v[140:143], a[156:159], a[176:179], v[140:143]
    buffer_load_dwordx4 v20, s[24:27], s66 offen offset:0 lds
    v_mfma_f32_16x16x32_bf16 v[140:143], a[140:143], a[172:175], v[140:143]
    s_and_b32 s48, s44, 1
    s_waitcnt lgkmcnt(2)
    v_mfma_f32_16x16x32_bf16 v[156:159], a[140:143], a[180:183], v[156:159]
    ds_read_b128 a[172:175], v26 offset:55296
    s_lshl_b32 s48, s48, 6
    v_mfma_f32_16x16x32_bf16 v[156:159], a[156:159], a[184:187], v[156:159]
    v_xor_b32 v34, s48, v34
    v_xor_b32 v35, 32, v34
    v_mfma_f32_16x16x32_bf16 v[152:155], a[152:155], a[184:187], v[152:155]
    buffer_load_dwordx4 v21, s[24:27], s66 offen offset:1024 lds
    v_mfma_f32_16x16x32_bf16 v[152:155], a[136:139], a[180:183], v[152:155]
    s_waitcnt vmcnt(12)
    s_waitcnt vmcnt(9)
    s_waitcnt lgkmcnt(0)
    s_cmp_ge_u32 s4, 8
    s_cbranch_scc0 Lgi_slow
Lgi_ok:
    s_barrier
    s_atomic_add s87, s[78:79], s56
    v_mfma_f32_16x16x32_bf16 v[148:151], a[132:135], a[180:183], v[148:151]
    ds_read_b128 a[176:179], v27 offset:55296
    ds_read_b64_tr_b16 a[96:97], v30 offset:32768
    v_mfma_f32_16x16x32_bf16 v[148:151], a[148:151], a[184:187], v[148:151]
    ds_read_b64_tr_b16 a[98:99], v30 offset:33792
    ds_read_b64_tr_b16 a[100:101], v31 offset:32768
    v_mfma_f32_16x16x32_bf16 v[144:147], a[144:147], a[184:187], v[144:147]
    buffer_load_dwordx4 v20, s[28:31], s66 offen offset:2048 lds
    v_mfma_f32_16x16x32_bf16 v[144:147], a[128:131], a[180:183], v[144:147]
    ds_read_b64_tr_b16 a[102:103], v31 offset:33792
    v_mfma_f32_16x16x32_bf16 v[160:163], a[128:131], a[188:191], v[160:163]
    ds_read_b128 a[180:183], v26 offset:57344
    ds_read_b64_tr_b16 a[104:105], v30 offset:34816
    v_mfma_f32_16x16x32_bf16 v[160:163], a[144:147], a[192:195], v[160:163]
    ds_read_b64_tr_b16 a[106:107], v30 offset:35840
    ds_read_b64_tr_b16 a[108:109], v31 offset:34816
    v_mfma_f32_16x16x32_bf16 v[164:167], a[148:151], a[192:195], v[164:167]
    buffer_load_dwordx4 v21, s[28:31], s66 offen offset:3072 lds
    v_mfma_f32_16x16x32_bf16 v[164:167], a[132:135], a[188:191], v[164:167]
    ds_read_b64_tr_b16 a[110:111], v31 offset:35840
    v_xor_b32_e64 v36, 64, v34
    v_mfma_f32_16x16x32_bf16 v[168:171], a[136:139], a[188:191], v[168:171]
    ds_read_b128 a[184:187], v27 offset:57344
    v_xor_b32 v37, 96, v34
    v_mfma_f32_16x16x32_bf16 v[168:171], a[152:155], a[192:195], v[168:171]
    s_add_u32 m0, s64, 16384
    s_xor_b32 s65, s65, 512
    v_mfma_f32_16x16x32_bf16 v[172:175], a[156:159], a[192:195], v[172:175]
    buffer_load_dwordx4 v16, s[20:23], s65 offen offset:0 lds
    v_mfma_f32_16x16x32_bf16 v[172:175], a[140:143], a[188:191], v[172:175]
    v_add_u32 v38, 65536, v34
    s_waitcnt lgkmcnt(10)
    v_mfma_f32_16x16x32_bf16 v[188:191], a[140:143], a[172:175], v[188:191]
    ds_read_b128 a[188:191], v26 offset:59392
    v_add_u32 v39, 65536, v35
    v_mfma_f32_16x16x32_bf16 v[188:191], a[156:159], a[176:179], v[188:191]
    s_add_u32 s68, s68, 1
    s_and_b32 s68, s68, 3
    s_or_b32 s68, s68, 4
    v_mfma_f32_16x16x32_bf16 v[184:187], a[152:155], a[176:179], v[184:187]
    buffer_load_dwordx4 v17, s[20:23], s65 offen offset:1024 lds
    v_mfma_f32_16x16x32_bf16 v[184:187], a[136:139], a[172:175], v[184:187]
    v_add_u32 v40, 65536, v36
    v_add_u32 v41, 65536, v37
    v_mfma_f32_16x16x32_bf16 v[180:183], a[132:135], a[172:175], v[180:183]
    ds_read_b128 a[192:195], v27 offset:59392
    v_add_u32 v42, 131072, v34
    v_mfma_f32_16x16x32_bf16 v[180:183], a[148:151], a[176:179], v[180:183]
    v_add_u32 v43, 131072, v35
    v_add_u32 v44, 131072, v36
    v_mfma_f32_16x16x32_bf16 v[176:179], a[144:147], a[176:179], v[176:179]
    buffer_load_dwordx4 v18, s[20:23], s65 offen offset:2048 lds
    v_mfma_f32_16x16x32_bf16 v[176:179], a[128:131], a[172:175], v[176:179]
    v_add_u32 v45, 131072, v37
    s_waitcnt lgkmcnt(2)
    v_mfma_f32_16x16x32_bf16 v[192:195], a[128:131], a[180:183], v[192:195]
    ds_read_b128 a[172:175], v26 offset:61440
    s_mul_i32 s48, s44, 458752
    v_mfma_f32_16x16x32_bf16 v[192:195], a[144:147], a[184:187], v[192:195]
    s_lshl_b32 s49, s7, 7
    s_add_u32 s48, s48, s49
    v_mfma_f32_16x16x32_bf16 v[196:199], a[148:151], a[184:187], v[196:199]
    buffer_load_dwordx4 v19, s[20:23], s65 offen offset:3072 lds
    v_mfma_f32_16x16x32_bf16 v[196:199], a[132:135], a[180:183], v[196:199]
    v_lshrrev_b32 v23, 3, v1
    v_lshl_add_u32 v23, v23, 10, s48
    v_mfma_f32_16x16x32_bf16 v[200:203], a[136:139], a[180:183], v[200:203]
    ds_read_b128 a[176:179], v27 offset:61440
    v_and_b32_e64 v22, 7, v1
    v_mfma_f32_16x16x32_bf16 v[200:203], a[152:155], a[184:187], v[200:203]
    s_add_u32 m0, s64, 147456
    s_add_u32 s66, s66, s67
    v_mfma_f32_16x16x32_bf16 v[204:207], a[156:159], a[184:187], v[204:207]
    buffer_load_dwordx4 v20, s[24:27], s66 offen offset:0 lds
    v_mfma_f32_16x16x32_bf16 v[204:207], a[140:143], a[180:183], v[204:207]
    v_lshlrev_b32 v24, 1, v3
    s_waitcnt lgkmcnt(2)
    v_mfma_f32_16x16x32_bf16 v[220:223], a[140:143], a[188:191], v[220:223]
    ds_read_b128 a[180:183], v26 offset:63488
    v_xor_b32 v22, v22, v24
    v_mfma_f32_16x16x32_bf16 v[220:223], a[156:159], a[192:195], v[220:223]
    v_lshl_add_u32 v22, v22, 4, v23
    v_add_u32 v23, 7168, v22
    v_mfma_f32_16x16x32_bf16 v[216:219], a[152:155], a[192:195], v[216:219]
    buffer_load_dwordx4 v21, s[24:27], s66 offen offset:1024 lds
    v_mfma_f32_16x16x32_bf16 v[216:219], a[136:139], a[188:191], v[216:219]
    s_waitcnt vmcnt(10)
    s_barrier
    v_mfma_f32_16x16x32_bf16 v[212:215], a[132:135], a[188:191], v[212:215]
    ds_read_b128 a[184:187], v27 offset:63488
    ds_read_b64_tr_b16 a[112:113], v30 offset:49152
    v_mfma_f32_16x16x32_bf16 v[212:215], a[148:151], a[192:195], v[212:215]
    ds_read_b64_tr_b16 a[114:115], v30 offset:50176
    ds_read_b64_tr_b16 a[116:117], v31 offset:49152
    v_mfma_f32_16x16x32_bf16 v[208:211], a[144:147], a[192:195], v[208:211]
    buffer_load_dwordx4 v20, s[28:31], s66 offen offset:2048 lds
    v_mfma_f32_16x16x32_bf16 v[208:211], a[128:131], a[188:191], v[208:211]
    ds_read_b64_tr_b16 a[118:119], v31 offset:50176
    s_waitcnt lgkmcnt(6)
    v_mfma_f32_16x16x32_bf16 v[224:227], a[128:131], a[172:175], v[224:227]
    ds_read_b128 a[188:191], v26 offset:0
    ds_read_b64_tr_b16 a[120:121], v30 offset:51200
    v_mfma_f32_16x16x32_bf16 v[224:227], a[144:147], a[176:179], v[224:227]
    ds_read_b64_tr_b16 a[122:123], v30 offset:52224
    ds_read_b64_tr_b16 a[124:125], v31 offset:51200
    v_mfma_f32_16x16x32_bf16 v[228:231], a[148:151], a[176:179], v[228:231]
    buffer_load_dwordx4 v21, s[28:31], s66 offen offset:3072 lds
    v_mfma_f32_16x16x32_bf16 v[228:231], a[132:135], a[172:175], v[228:231]
    ds_read_b64_tr_b16 a[126:127], v31 offset:52224
    v_add_u32 v24, 14336, v22
    v_mfma_f32_16x16x32_bf16 v[232:235], a[136:139], a[172:175], v[232:235]
    ds_read_b128 a[192:195], v27 offset:0
    v_add_u32 v25, 21504, v22
    v_mfma_f32_16x16x32_bf16 v[232:235], a[152:155], a[176:179], v[232:235]
    s_add_u32 m0, s64, 65536
    s_mul_i32 s66, s69, s15
    v_mfma_f32_16x16x32_bf16 v[236:239], a[156:159], a[176:179], v[236:239]
    buffer_load_dwordx4 v20, s[24:27], s66 offen offset:0 lds
    v_mfma_f32_16x16x32_bf16 v[236:239], a[140:143], a[172:175], v[236:239]
    s_mov_b32 s3, 0xffff0000
    s_waitcnt lgkmcnt(10)
    v_mfma_f32_16x16x32_bf16 v[252:255], a[140:143], a[180:183], v[252:255]
    ds_read_b128 a[172:175], v26 offset:2048
Lpad_g0:
    s_cbranch_execz Lret_g
    v_mfma_f32_16x16x32_bf16 v[252:255], a[156:159], a[184:187], v[252:255]
    v_mfma_f32_16x16x32_bf16 v[248:251], a[152:155], a[184:187], v[248:251]
    buffer_load_dwordx4 v21, s[24:27], s66 offen offset:1024 lds
    v_mfma_f32_16x16x32_bf16 v[248:251], a[136:139], a[180:183], v[248:251]
    v_mfma_f32_16x16x32_bf16 v[244:247], a[132:135], a[180:183], v[244:247]
    ds_read_b128 a[176:179], v27 offset:2048
    v_mfma_f32_16x16x32_bf16 v[244:247], a[148:151], a[184:187], v[244:247]
    v_mfma_f32_16x16x32_bf16 v[240:243], a[144:147], a[184:187], v[240:243]
    buffer_load_dwordx4 v20, s[28:31], s66 offen offset:2048 lds
    v_mfma_f32_16x16x32_bf16 v[240:243], a[128:131], a[180:183], v[240:243]
    s_waitcnt lgkmcnt(2)
    v_mfma_f32_16x16x32_bf16 v[128:131], a[96:99], a[188:191], v[128:131]
    ds_read_b128 a[180:183], v26 offset:4096
    s_load_dword s4, s[78:79], s56 glc
    v_mfma_f32_16x16x32_bf16 v[128:131], a[112:115], a[192:195], v[128:131]
    v_mfma_f32_16x16x32_bf16 v[132:135], a[116:119], a[192:195], v[132:135]
    buffer_load_dwordx4 v21, s[28:31], s66 offen offset:3072 lds
    v_mfma_f32_16x16x32_bf16 v[132:135], a[100:103], a[188:191], v[132:135]
    v_mfma_f32_16x16x32_bf16 v[136:139], a[104:107], a[188:191], v[136:139]
    ds_read_b128 a[184:187], v27 offset:4096
    v_mfma_f32_16x16x32_bf16 v[136:139], a[120:123], a[192:195], v[136:139]
    s_add_u32 m0, s64, 32768
    s_lshl_b32 s65, s68, 7
    v_mfma_f32_16x16x32_bf16 v[140:143], a[124:127], a[192:195], v[140:143]
    buffer_load_dwordx4 v16, s[20:23], s65 offen offset:0 lds
    v_mfma_f32_16x16x32_bf16 v[140:143], a[108:111], a[188:191], v[140:143]
    s_waitcnt lgkmcnt(2)
    v_mfma_f32_16x16x32_bf16 v[156:159], a[108:111], a[172:175], v[156:159]
    ds_read_b128 a[188:191], v26 offset:6144
    v_mfma_f32_16x16x32_bf16 v[156:159], a[124:127], a[176:179], v[156:159]
    v_mfma_f32_16x16x32_bf16 v[152:155], a[120:123], a[176:179], v[152:155]
    buffer_load_dwordx4 v17, s[20:23], s65 offen offset:1024 lds
    v_mfma_f32_16x16x32_bf16 v[152:155], a[104:107], a[172:175], v[152:155]
    s_waitcnt vmcnt(14)
    s_barrier
    v_mfma_f32_16x16x32_bf16 v[148:151], a[100:103], a[172:175], v[148:151]
    ds_read_b128 a[192:195], v27 offset:6144
    ds_read_b64_tr_b16 a[128:129], v32 offset:0
    v_mfma_f32_16x16x32_bf16 v[148:151], a[116:119], a[176:179], v[148:151]
    ds_read_b64_tr_b16 a[130:131], v32 offset:1024
    ds_read_b64_tr_b16 a[132:133], v33 offset:0
    v_mfma_f32_16x16x32_bf16 v[144:147], a[112:115], a[176:179], v[144:147]
    buffer_load_dwordx4 v18, s[20:23], s65 offen offset:2048 lds
    v_mfma_f32_16x16x32_bf16 v[144:147], a[96:99], a[172:175], v[144:147]
    ds_read_b64_tr_b16 a[134:135], v33 offset:1024
    s_waitcnt lgkmcnt(6)
    v_mfma_f32_16x16x32_bf16 v[160:163], a[96:99], a[180:183], v[160:163]
    ds_read_b128 a[172:175], v26 offset:8192
    ds_read_b64_tr_b16 a[136:137], v32 offset:2048
    v_mfma_f32_16x16x32_bf16 v[160:163], a[112:115], a[184:187], v[160:163]
    ds_read_b64_tr_b16 a[138:139], v32 offset:3072
    ds_read_b64_tr_b16 a[140:141], v33 offset:2048
    v_mfma_f32_16x16x32_bf16 v[164:167], a[116:119], a[184:187], v[164:167]
    buffer_load_dwordx4 v19, s[20:23], s65 offen offset:3072 lds
    v_mfma_f32_16x16x32_bf16 v[164:167], a[100:103], a[180:183], v[164:167]
    ds_read_b64_tr_b16 a[142:143], v33 offset:3072
    v_mfma_f32_16x16x32_bf16 v[168:171], a[104:107], a[180:183], v[168:171]
    ds_read_b128 a[176:179], v27 offset:8192
    v_mfma_f32_16x16x32_bf16 v[168:171], a[120:123], a[184:187], v[168:171]
    s_add_u32 m0, s64, 81920
    s_add_u32 s66, s66, s67
    v_mfma_f32_16x16x32_bf16 v[172:175], a[124:127], a[184:187], v[172:175]
    buffer_load_dwordx4 v20, s[24:27], s66 offen offset:0 lds
    v_mfma_f32_16x16x32_bf16 v[172:175], a[108:111], a[180:183], v[172:175]
    s_waitcnt lgkmcnt(10)
    v_mfma_f32_16x16x32_bf16 v[188:191], a[108:111], a[188:191], v[188:191]
    ds_read_b128 a[180:183], v26 offset:10240
    v_mfma_f32_16x16x32_bf16 v[188:191], a[124:127], a[192:195], v[188:191]
    s_add_u32 s69, s69, 1
    s_and_b32 s69, s69, 3
    s_or_b32 s69, s69, 4
    v_mfma_f32_16x16x32_bf16 v[184:187], a[120:123], a[192:195], v[184:187]
    buffer_load_dwordx4 v21, s[24:27], s66 offen offset:1024 lds
    v_mfma_f32_16x16x32_bf16 v[184:187], a[104:107], a[188:191], v[184:187]
    v_mfma_f32_16x16x32_bf16 v[180:183], a[100:103], a[188:191], v[180:183]
    ds_read_b128 a[184:187], v27 offset:10240
    v_mfma_f32_16x16x32_bf16 v[180:183], a[116:119], a[192:195], v[180:183]
    v_mfma_f32_16x16x32_bf16 v[176:179], a[112:115], a[192:195], v[176:179]
    buffer_load_dwordx4 v20, s[28:31], s66 offen offset:2048 lds
    v_mfma_f32_16x16x32_bf16 v[176:179], a[96:99], a[188:191], v[176:179]
    s_waitcnt lgkmcnt(2)
    v_mfma_f32_16x16x32_bf16 v[192:195], a[96:99], a[172:175], v[192:195]
    ds_read_b128 a[188:191], v26 offset:12288
    v_mfma_f32_16x16x32_bf16 v[192:195], a[112:115], a[176:179], v[192:195]
    v_mfma_f32_16x16x32_bf16 v[196:199], a[116:119], a[176:179], v[196:199]
    buffer_load_dwordx4 v21, s[28:31], s66 offen offset:3072 lds
    v_mfma_f32_16x16x32_bf16 v[196:199], a[100:103], a[172:175], v[196:199]
    v_mfma_f32_16x16x32_bf16 v[200:203], a[104:107], a[172:175], v[200:203]
    ds_read_b128 a[192:195], v27 offset:12288
    v_mfma_f32_16x16x32_bf16 v[200:203], a[120:123], a[176:179], v[200:203]
    s_add_u32 m0, s64, 98304
    s_add_u32 s66, s66, s0
    v_mfma_f32_16x16x32_bf16 v[204:207], a[124:127], a[176:179], v[204:207]
    buffer_load_dwordx4 v20, s[24:27], s66 offen offset:0 lds
    v_mfma_f32_16x16x32_bf16 v[204:207], a[108:111], a[172:175], v[204:207]
    s_waitcnt lgkmcnt(2)
    v_mfma_f32_16x16x32_bf16 v[220:223], a[108:111], a[180:183], v[220:223]
    ds_read_b128 a[172:175], v26 offset:14336
    v_mfma_f32_16x16x32_bf16 v[220:223], a[124:127], a[184:187], v[220:223]
    v_mfma_f32_16x16x32_bf16 v[216:219], a[120:123], a[184:187], v[216:219]
    buffer_load_dwordx4 v21, s[24:27], s66 offen offset:1024 lds
    v_mfma_f32_16x16x32_bf16 v[216:219], a[104:107], a[180:183], v[216:219]
    s_waitcnt vmcnt(14)
    s_waitcnt lgkmcnt(0)
    s_cmp_ge_u32 s4, s53
    s_cbranch_scc0 Lgs_slow
Lgs_ok:
    s_barrier
    v_mfma_f32_16x16x32_bf16 v[212:215], a[100:103], a[180:183], v[212:215]
    ds_read_b128 a[176:179], v27 offset:14336
    ds_read_b64_tr_b16 a[144:145], v32 offset:16384
    v_mfma_f32_16x16x32_bf16 v[212:215], a[116:119], a[184:187], v[212:215]
    ds_read_b64_tr_b16 a[146:147], v32 offset:17408
    ds_read_b64_tr_b16 a[148:149], v33 offset:16384
    v_mfma_f32_16x16x32_bf16 v[208:211], a[112:115], a[184:187], v[208:211]
    buffer_load_dwordx4 v[96:99], v15, s[32:35], s71 offen sc1
    v_mfma_f32_16x16x32_bf16 v[208:211], a[96:99], a[180:183], v[208:211]
    ds_read_b64_tr_b16 a[150:151], v33 offset:17408
    v_mfma_f32_16x16x32_bf16 v[224:227], a[96:99], a[188:191], v[224:227]
    ds_read_b128 a[180:183], v26 offset:16384
    ds_read_b64_tr_b16 a[152:153], v32 offset:18432
    v_mfma_f32_16x16x32_bf16 v[224:227], a[112:115], a[192:195], v[224:227]
    ds_read_b64_tr_b16 a[154:155], v32 offset:19456
    ds_read_b64_tr_b16 a[156:157], v33 offset:18432
    v_mfma_f32_16x16x32_bf16 v[228:231], a[116:119], a[192:195], v[228:231]
    buffer_load_dwordx4 v[112:115], v15, s[32:35], s81 offen sc1
    v_mfma_f32_16x16x32_bf16 v[228:231], a[100:103], a[188:191], v[228:231]
    ds_read_b64_tr_b16 a[158:159], v33 offset:19456
    v_mfma_f32_16x16x32_bf16 v[232:235], a[104:107], a[188:191], v[232:235]
    ds_read_b128 a[184:187], v27 offset:16384
    v_mfma_f32_16x16x32_bf16 v[232:235], a[120:123], a[192:195], v[232:235]
    v_mfma_f32_16x16x32_bf16 v[236:239], a[124:127], a[192:195], v[236:239]
    buffer_load_dwordx4 v20, s[28:31], s66 offen offset:2048 lds
    v_mfma_f32_16x16x32_bf16 v[236:239], a[108:111], a[188:191], v[236:239]
    s_waitcnt lgkmcnt(10)
    v_mfma_f32_16x16x32_bf16 v[252:255], a[108:111], a[172:175], v[252:255]
    ds_read_b128 a[188:191], v26 offset:18432
    v_mfma_f32_16x16x32_bf16 v[252:255], a[124:127], a[176:179], v[252:255]
    v_mfma_f32_16x16x32_bf16 v[248:251], a[120:123], a[176:179], v[248:251]
    buffer_load_dwordx4 v21, s[28:31], s66 offen offset:3072 lds
    v_mfma_f32_16x16x32_bf16 v[248:251], a[104:107], a[172:175], v[248:251]
    v_mfma_f32_16x16x32_bf16 v[244:247], a[100:103], a[172:175], v[244:247]
    ds_read_b128 a[192:195], v27 offset:18432
    v_mfma_f32_16x16x32_bf16 v[244:247], a[116:119], a[176:179], v[244:247]
    s_add_u32 m0, s64, 49152
    s_xor_b32 s65, s65, 512
    v_mfma_f32_16x16x32_bf16 v[240:243], a[112:115], a[176:179], v[240:243]
    buffer_load_dwordx4 v16, s[20:23], s65 offen offset:0 lds
    v_mfma_f32_16x16x32_bf16 v[240:243], a[96:99], a[172:175], v[240:243]
    s_waitcnt lgkmcnt(2)
    v_mfma_f32_16x16x32_bf16 v[128:131], a[128:131], a[180:183], v[128:131]
    ds_read_b128 a[172:175], v26 offset:20480
    v_mfma_f32_16x16x32_bf16 v[128:131], a[144:147], a[184:187], v[128:131]
    s_add_u32 s68, s68, 1
    s_and_b32 s68, s68, 3
    s_or_b32 s68, s68, 4
    v_mfma_f32_16x16x32_bf16 v[132:135], a[148:151], a[184:187], v[132:135]
    buffer_load_dwordx4 v17, s[20:23], s65 offen offset:1024 lds
    v_mfma_f32_16x16x32_bf16 v[132:135], a[132:135], a[180:183], v[132:135]
    v_mfma_f32_16x16x32_bf16 v[136:139], a[136:139], a[180:183], v[136:139]
    ds_read_b128 a[176:179], v27 offset:20480
    v_mfma_f32_16x16x32_bf16 v[136:139], a[152:155], a[184:187], v[136:139]
    v_mfma_f32_16x16x32_bf16 v[140:143], a[156:159], a[184:187], v[140:143]
    buffer_load_dwordx4 v18, s[20:23], s65 offen offset:2048 lds
    v_mfma_f32_16x16x32_bf16 v[140:143], a[140:143], a[180:183], v[140:143]
    s_waitcnt lgkmcnt(2)
    v_mfma_f32_16x16x32_bf16 v[156:159], a[140:143], a[188:191], v[156:159]
    ds_read_b128 a[180:183], v26 offset:22528
    v_mfma_f32_16x16x32_bf16 v[156:159], a[156:159], a[192:195], v[156:159]
    v_mfma_f32_16x16x32_bf16 v[152:155], a[152:155], a[192:195], v[152:155]
    buffer_load_dwordx4 v19, s[20:23], s65 offen offset:3072 lds
    v_mfma_f32_16x16x32_bf16 v[152:155], a[136:139], a[188:191], v[152:155]
    s_waitcnt vmcnt(18)
    s_barrier
    v_mfma_f32_16x16x32_bf16 v[148:151], a[132:135], a[188:191], v[148:151]
    ds_read_b128 a[184:187], v27 offset:22528
    ds_read_b64_tr_b16 a[96:97], v30 offset:0
    v_mfma_f32_16x16x32_bf16 v[148:151], a[148:151], a[192:195], v[148:151]
    s_add_u32 m0, s64, 114688
    s_add_u32 s66, s66, s67
    v_mfma_f32_16x16x32_bf16 v[144:147], a[144:147], a[192:195], v[144:147]
    buffer_load_dwordx4 v20, s[24:27], s66 offen offset:0 lds
    v_mfma_f32_16x16x32_bf16 v[144:147], a[128:131], a[188:191], v[144:147]
    ds_read_b64_tr_b16 a[98:99], v30 offset:1024
    s_waitcnt lgkmcnt(4)
    v_mfma_f32_16x16x32_bf16 v[160:163], a[128:131], a[172:175], v[160:163]
    ds_read_b128 a[188:191], v26 offset:24576
    ds_read_b64_tr_b16 a[100:101], v31 offset:0
    v_mfma_f32_16x16x32_bf16 v[160:163], a[144:147], a[176:179], v[160:163]
    ds_read_b64_tr_b16 a[102:103], v31 offset:1024
    ds_read_b64_tr_b16 a[104:105], v30 offset:2048
    v_mfma_f32_16x16x32_bf16 v[164:167], a[148:151], a[176:179], v[164:167]
    buffer_load_dwordx4 v21, s[24:27], s66 offen offset:1024 lds
    v_mfma_f32_16x16x32_bf16 v[164:167], a[132:135], a[172:175], v[164:167]
    ds_read_b64_tr_b16 a[106:107], v30 offset:3072
    ds_read_b64_tr_b16 a[108:109], v31 offset:2048
    v_mfma_f32_16x16x32_bf16 v[168:171], a[136:139], a[172:175], v[168:171]
    ds_read_b128 a[192:195], v27 offset:24576
    ds_read_b64_tr_b16 a[110:111], v31 offset:3072
    v_mfma_f32_16x16x32_bf16 v[168:171], a[152:155], a[176:179], v[168:171]
    v_mfma_f32_16x16x32_bf16 v[172:175], a[156:159], a[176:179], v[172:175]
    buffer_load_dwordx4 v20, s[28:31], s66 offen offset:2048 lds
    v_mfma_f32_16x16x32_bf16 v[172:175], a[140:143], a[172:175], v[172:175]
    s_waitcnt lgkmcnt(10)
    v_mfma_f32_16x16x32_bf16 v[188:191], a[140:143], a[180:183], v[188:191]
    ds_read_b128 a[172:175], v26 offset:26624
    v_mfma_f32_16x16x32_bf16 v[188:191], a[156:159], a[184:187], v[188:191]
    v_mfma_f32_16x16x32_bf16 v[184:187], a[152:155], a[184:187], v[184:187]
    buffer_load_dwordx4 v21, s[28:31], s66 offen offset:3072 lds
    v_mfma_f32_16x16x32_bf16 v[184:187], a[136:139], a[180:183], v[184:187]
    v_mfma_f32_16x16x32_bf16 v[180:183], a[132:135], a[180:183], v[180:183]
    ds_read_b128 a[176:179], v27 offset:26624
    v_mfma_f32_16x16x32_bf16 v[180:183], a[148:151], a[184:187], v[180:183]
    s_add_u32 m0, s64, 131072
    s_lshl_b32 s5, s8, 5
    v_mfma_f32_16x16x32_bf16 v[176:179], a[144:147], a[184:187], v[176:179]
    buffer_load_dwordx4 v22, s[36:39], s5 offen offset:0 lds
    v_mfma_f32_16x16x32_bf16 v[176:179], a[128:131], a[180:183], v[176:179]
    s_waitcnt lgkmcnt(3)
    v_mfma_f32_16x16x32_bf16 v[192:195], a[128:131], a[188:191], v[192:195]
    ds_read_b128 a[180:183], v26 offset:28672
    v_mfma_f32_16x16x32_bf16 v[192:195], a[144:147], a[192:195], v[192:195]
    v_mfma_f32_16x16x32_bf16 v[196:199], a[148:151], a[192:195], v[196:199]
    buffer_load_dwordx4 v23, s[36:39], s5 offen offset:1024 lds
    v_mfma_f32_16x16x32_bf16 v[196:199], a[132:135], a[188:191], v[196:199]
    v_mfma_f32_16x16x32_bf16 v[200:203], a[136:139], a[188:191], v[200:203]
    ds_read_b128 a[184:187], v27 offset:28672
    s_lshl_b32 s48, s44, 9
    v_mfma_f32_16x16x32_bf16 v[200:203], a[152:155], a[192:195], v[200:203]
    s_add_u32 s48, s48, 16384
    s_waitcnt vmcnt(13)
    v_permlane32_swap_b32 v96, v98
    v_mfma_f32_16x16x32_bf16 v[204:207], a[156:159], a[192:195], v[204:207]
    buffer_load_dwordx4 v24, s[36:39], s5 offen offset:2048 lds
    v_mfma_f32_16x16x32_bf16 v[204:207], a[140:143], a[188:191], v[204:207]
    v_permlane32_swap_b32 v97, v99
    s_waitcnt lgkmcnt(2)
    v_mfma_f32_16x16x32_bf16 v[220:223], a[140:143], a[172:175], v[220:223]
    ds_read_b128 a[188:191], v26 offset:30720
    s_waitcnt vmcnt(13)
    v_permlane32_swap_b32 v112, v114
    v_mfma_f32_16x16x32_bf16 v[220:223], a[156:159], a[176:179], v[220:223]
    v_permlane32_swap_b32 v113, v115
    v_add_f32_e64 v100, v96, v98
    v_mfma_f32_16x16x32_bf16 v[216:219], a[152:155], a[176:179], v[216:219]
    buffer_load_dwordx4 v25, s[36:39], s5 offen offset:3072 lds
    v_mfma_f32_16x16x32_bf16 v[216:219], a[136:139], a[172:175], v[216:219]
    s_barrier
    v_mfma_f32_16x16x32_bf16 v[212:215], a[132:135], a[172:175], v[212:215]
    ds_read_b128 a[192:195], v27 offset:30720
    ds_read_b64_tr_b16 a[112:113], v30 offset:16384
    v_mfma_f32_16x16x32_bf16 v[212:215], a[148:151], a[176:179], v[212:215]
    s_add_u32 m0, s64, 147456
    s_add_u32 s5, s5, 32768
    v_mfma_f32_16x16x32_bf16 v[208:211], a[144:147], a[176:179], v[208:211]
    buffer_load_dwordx4 v22, s[36:39], s5 offen offset:0 lds
    v_mfma_f32_16x16x32_bf16 v[208:211], a[128:131], a[172:175], v[208:211]
    ds_read_b64_tr_b16 a[114:115], v30 offset:17408
    s_waitcnt lgkmcnt(4)
    v_mfma_f32_16x16x32_bf16 v[224:227], a[128:131], a[180:183], v[224:227]
    ds_read_b128 a[172:175], v26 offset:32768
    ds_read_b64_tr_b16 a[116:117], v31 offset:16384
    v_mfma_f32_16x16x32_bf16 v[224:227], a[144:147], a[184:187], v[224:227]
    ds_read_b64_tr_b16 a[118:119], v31 offset:17408
    ds_read_b64_tr_b16 a[120:121], v30 offset:18432
    v_mfma_f32_16x16x32_bf16 v[228:231], a[148:151], a[184:187], v[228:231]
    buffer_load_dwordx4 v23, s[36:39], s5 offen offset:1024 lds
    v_mfma_f32_16x16x32_bf16 v[228:231], a[132:135], a[180:183], v[228:231]
    ds_read_b64_tr_b16 a[122:123], v30 offset:19456
    ds_read_b64_tr_b16 a[124:125], v31 offset:18432
    v_mfma_f32_16x16x32_bf16 v[232:235], a[136:139], a[180:183], v[232:235]
    ds_read_b128 a[176:179], v27 offset:32768
    ds_read_b64_tr_b16 a[126:127], v31 offset:19456
    v_mfma_f32_16x16x32_bf16 v[232:235], a[152:155], a[184:187], v[232:235]
    v_add_f32 v101, v97, v99
    v_add_f32 v96, v96, v98
    v_mfma_f32_16x16x32_bf16 v[236:239], a[156:159], a[184:187], v[236:239]
    buffer_load_dwordx4 v24, s[36:39], s5 offen offset:2048 lds
    v_mfma_f32_16x16x32_bf16 v[236:239], a[140:143], a[180:183], v[236:239]
    v_add_f32 v97, v97, v99
    s_waitcnt lgkmcnt(10)
    v_mfma_f32_16x16x32_bf16 v[252:255], a[140:143], a[188:191], v[252:255]
    ds_read_b128 a[180:183], v26 offset:34816
    v_add_f32_e64 v112, v112, v114
    v_mfma_f32_16x16x32_bf16 v[252:255], a[156:159], a[192:195], v[252:255]
    v_add_f32 v113, v113, v115
    v_lshrrev_b32 v14, 1, v3
    v_mfma_f32_16x16x32_bf16 v[248:251], a[152:155], a[192:195], v[248:251]
    buffer_load_dwordx4 v25, s[36:39], s5 offen offset:3072 lds
    v_mfma_f32_16x16x32_bf16 v[248:251], a[136:139], a[188:191], v[248:251]
    v_lshl_add_u32 v14, v2, 1, v14
    v_permlane16_swap_b32 v96, v100
    v_mfma_f32_16x16x32_bf16 v[244:247], a[132:135], a[188:191], v[244:247]
    ds_read_b128 a[184:187], v27 offset:34816
    v_permlane16_swap_b32 v97, v101
    v_mfma_f32_16x16x32_bf16 v[244:247], a[148:151], a[192:195], v[244:247]
    s_add_u32 m0, s64, 0
    s_lshl_b32 s5, s9, 5
    v_mfma_f32_16x16x32_bf16 v[240:243], a[144:147], a[192:195], v[240:243]
    buffer_load_dwordx4 v22, s[36:39], s5 offen offset:0 lds
    v_mfma_f32_16x16x32_bf16 v[240:243], a[128:131], a[188:191], v[240:243]
    v_permlane16_swap_b32 v112, v113
    s_waitcnt lgkmcnt(3)
    v_mfma_f32_16x16x32_bf16 v[128:131], a[96:99], a[172:175], v[128:131]
    ds_read_b128 a[188:191], v26 offset:36864
    v_lshl_add_u32 v14, v14, 4, s48
    v_mfma_f32_16x16x32_bf16 v[128:131], a[112:115], a[176:179], v[128:131]
    v_add_f32 v96, v96, v100
    v_add_f32 v97, v97, v101
    v_mfma_f32_16x16x32_bf16 v[132:135], a[116:119], a[176:179], v[132:135]
    buffer_load_dwordx4 v23, s[36:39], s5 offen offset:1024 lds
    v_mfma_f32_16x16x32_bf16 v[132:135], a[100:103], a[172:175], v[132:135]
    v_add_f32 v98, v112, v113
    s_lshl_b32 s48, s44, 8
    v_mfma_f32_16x16x32_bf16 v[136:139], a[104:107], a[172:175], v[136:139]
    ds_read_b128 a[192:195], v27 offset:36864
    s_add_u32 s48, s48, 20480
    v_mfma_f32_16x16x32_bf16 v[136:139], a[120:123], a[176:179], v[136:139]
    v_lshl_add_u32 v8, v2, 2, v3
    v_lshl_add_u32 v8, v8, 2, s48
    s_waitcnt lgkmcnt(4)
    v_mfma_f32_16x16x32_bf16 v[140:143], a[124:127], a[176:179], v[140:143]
    buffer_load_dwordx4 v24, s[36:39], s5 offen offset:2048 lds
    v_mfma_f32_16x16x32_bf16 v[140:143], a[108:111], a[172:175], v[140:143]
    v_lshl_add_u32 v9, v3, 4, s48
    s_waitcnt lgkmcnt(2)
    v_mfma_f32_16x16x32_bf16 v[156:159], a[108:111], a[180:183], v[156:159]
    ds_read_b128 a[172:175], v26 offset:38912
    v_mul_f32 v4, 0xbb000000, v96
    v_mfma_f32_16x16x32_bf16 v[156:159], a[124:127], a[184:187], v[156:159]
    v_mul_f32 v97, 0x3b000000, v97
    v_fma_f32 v97, -v4, v4, v97
    v_mfma_f32_16x16x32_bf16 v[152:155], a[120:123], a[184:187], v[152:155]
    buffer_load_dwordx4 v25, s[36:39], s5 offen offset:3072 lds
    v_mfma_f32_16x16x32_bf16 v[152:155], a[104:107], a[180:183], v[152:155]
    s_waitcnt vmcnt(20)
    s_barrier
    v_mfma_f32_16x16x32_bf16 v[148:151], a[100:103], a[180:183], v[148:151]
    ds_read_b128 a[176:179], v27 offset:38912
    ds_read_b64_tr_b16 a[128:129], v30 offset:32768
    v_mfma_f32_16x16x32_bf16 v[148:151], a[116:119], a[184:187], v[148:151]
    s_add_u32 m0, s64, 65536
    s_add_u32 s5, s5, 32768
    v_mfma_f32_16x16x32_bf16 v[144:147], a[112:115], a[184:187], v[144:147]
    buffer_load_dwordx4 v22, s[36:39], s5 offen offset:0 lds
    v_mfma_f32_16x16x32_bf16 v[144:147], a[96:99], a[180:183], v[144:147]
    ds_read_b64_tr_b16 a[130:131], v30 offset:33792
    s_waitcnt lgkmcnt(4)
    v_mfma_f32_16x16x32_bf16 v[160:163], a[96:99], a[188:191], v[160:163]
    ds_read_b128 a[180:183], v26 offset:40960
    ds_read_b64_tr_b16 a[132:133], v31 offset:32768
    v_mfma_f32_16x16x32_bf16 v[160:163], a[112:115], a[192:195], v[160:163]
    ds_read_b64_tr_b16 a[134:135], v31 offset:33792
    ds_read_b64_tr_b16 a[136:137], v30 offset:34816
    v_mfma_f32_16x16x32_bf16 v[164:167], a[116:119], a[192:195], v[164:167]
    buffer_load_dwordx4 v23, s[36:39], s5 offen offset:1024 lds
    v_mfma_f32_16x16x32_bf16 v[164:167], a[100:103], a[188:191], v[164:167]
    ds_read_b64_tr_b16 a[138:139], v30 offset:35840
    ds_read_b64_tr_b16 a[140:141], v31 offset:34816
    v_mfma_f32_16x16x32_bf16 v[168:171], a[104:107], a[188:191], v[168:171]
    ds_read_b128 a[184:187], v27 offset:40960
    ds_read_b64_tr_b16 a[142:143], v31 offset:35840
    v_mfma_f32_16x16x32_bf16 v[168:171], a[120:123], a[192:195], v[168:171]
    v_max_f32 v97, 0, v97
    v_add_f32 v97, 0x3727c5ac, v97
    v_mfma_f32_16x16x32_bf16 v[172:175], a[124:127], a[192:195], v[172:175]
    buffer_load_dwordx4 v24, s[36:39], s5 offen offset:2048 lds
    v_mfma_f32_16x16x32_bf16 v[172:175], a[108:111], a[188:191], v[172:175]
    v_rsq_f32 v7, v97
    s_waitcnt lgkmcnt(10)
    v_mfma_f32_16x16x32_bf16 v[188:191], a[108:111], a[172:175], v[188:191]
    ds_read_b128 a[188:191], v26 offset:43008
    v_sqrt_f32_e64 v5, v97
    v_mfma_f32_16x16x32_bf16 v[188:191], a[124:127], a[176:179], v[188:191]
    v_mul_f32 v6, 0xbfb8aa3b, v7
    v_lshlrev_b32_e64 v15, 4, v2
    v_mfma_f32_16x16x32_bf16 v[184:187], a[120:123], a[176:179], v[184:187]
    buffer_load_dwordx4 v25, s[36:39], s5 offen offset:3072 lds
    v_mfma_f32_16x16x32_bf16 v[184:187], a[104:107], a[172:175], v[184:187]
    ds_write_b32 v8, v98
    ds_write_b128 v14, v[4:7]
    v_mfma_f32_16x16x32_bf16 v[180:183], a[100:103], a[172:175], v[180:183]
    ds_read_b128 a[192:195], v27 offset:43008
    ds_read_b128 v[104:107], v9 offset:0
    v_mfma_f32_16x16x32_bf16 v[180:183], a[116:119], a[176:179], v[180:183]
    s_add_u32 m0, s64, 81920
    s_lshl_b32 s5, s10, 5
    v_mfma_f32_16x16x32_bf16 v[176:179], a[112:115], a[176:179], v[176:179]
    buffer_load_dwordx4 v22, s[36:39], s5 offen offset:0 lds
    v_mfma_f32_16x16x32_bf16 v[176:179], a[96:99], a[172:175], v[176:179]
    ds_read_b128 v[108:111], v9 offset:64
    s_waitcnt lgkmcnt(7)
    v_mfma_f32_16x16x32_bf16 v[192:195], a[96:99], a[180:183], v[192:195]
    ds_read_b128 a[172:175], v26 offset:45056
    ds_read_b128 v[112:115], v9 offset:128
    v_mfma_f32_16x16x32_bf16 v[192:195], a[112:115], a[184:187], v[192:195]
    ds_read_b128 v[116:119], v9 offset:192
    s_mul_i32 s50, s45, 458752
    v_mfma_f32_16x16x32_bf16 v[196:199], a[116:119], a[184:187], v[196:199]
    buffer_load_dwordx4 v23, s[36:39], s5 offen offset:1024 lds
    v_mfma_f32_16x16x32_bf16 v[196:199], a[100:103], a[180:183], v[196:199]
    s_lshl_b32 s49, s46, 2
    s_add_u32 s49, s49, s44
    v_mfma_f32_16x16x32_bf16 v[200:203], a[104:107], a[180:183], v[200:203]
    ds_read_b128 a[176:179], v27 offset:45056
    s_mul_i32 s60, s49, 4682
    v_mfma_f32_16x16x32_bf16 v[200:203], a[120:123], a[184:187], v[200:203]
    s_lshl_b32 s49, s49, 10
    s_add_u32 s52, s50, s49
    v_mfma_f32_16x16x32_bf16 v[204:207], a[124:127], a[184:187], v[204:207]
    buffer_load_dwordx4 v24, s[36:39], s5 offen offset:2048 lds
    v_mfma_f32_16x16x32_bf16 v[204:207], a[108:111], a[180:183], v[204:207]
    v_lshlrev_b32 v16, 4, v1
    s_waitcnt lgkmcnt(6)
    v_mfma_f32_16x16x32_bf16 v[220:223], a[108:111], a[188:191], v[220:223]
    ds_read_b128 a[180:183], v26 offset:47104
    s_lshr_b32 s60, s60, 16
    v_mfma_f32_16x16x32_bf16 v[220:223], a[124:127], a[192:195], v[220:223]
    s_lshl_b32 s49, s45, 2
    s_add_u32 s60, s60, s49
    v_mfma_f32_16x16x32_bf16 v[216:219], a[120:123], a[192:195], v[216:219]
    buffer_load_dwordx4 v25, s[36:39], s5 offen offset:3072 lds
    v_mfma_f32_16x16x32_bf16 v[216:219], a[104:107], a[188:191], v[216:219]
    s_waitcnt vmcnt(20)
    s_barrier
    v_mfma_f32_16x16x32_bf16 v[212:215], a[100:103], a[188:191], v[212:215]
    ds_read_b128 a[184:187], v27 offset:47104
    ds_read_b64_tr_b16 a[144:145], v30 offset:49152
    v_mfma_f32_16x16x32_bf16 v[212:215], a[116:119], a[192:195], v[212:215]
    s_add_u32 m0, s64, 98304
    s_add_u32 s5, s5, 32768
    v_mfma_f32_16x16x32_bf16 v[208:211], a[112:115], a[192:195], v[208:211]
    buffer_load_dwordx4 v22, s[36:39], s5 offen offset:0 lds
    v_mfma_f32_16x16x32_bf16 v[208:211], a[96:99], a[188:191], v[208:211]
    ds_read_b64_tr_b16 a[146:147], v30 offset:50176
    s_waitcnt lgkmcnt(4)
    v_mfma_f32_16x16x32_bf16 v[224:227], a[96:99], a[172:175], v[224:227]
    ds_read_b128 a[188:191], v26 offset:49152
    ds_read_b64_tr_b16 a[148:149], v31 offset:49152
    v_mfma_f32_16x16x32_bf16 v[224:227], a[112:115], a[176:179], v[224:227]
    ds_read_b64_tr_b16 a[150:151], v31 offset:50176
    ds_read_b64_tr_b16 a[152:153], v30 offset:51200
    v_mfma_f32_16x16x32_bf16 v[228:231], a[116:119], a[176:179], v[228:231]
    buffer_load_dwordx4 v23, s[36:39], s5 offen offset:1024 lds
    v_mfma_f32_16x16x32_bf16 v[228:231], a[100:103], a[172:175], v[228:231]
    ds_read_b64_tr_b16 a[154:155], v30 offset:52224
    ds_read_b64_tr_b16 a[156:157], v31 offset:51200
    v_mfma_f32_16x16x32_bf16 v[232:235], a[104:107], a[172:175], v[232:235]
    ds_read_b128 a[192:195], v27 offset:49152
    ds_read_b64_tr_b16 a[158:159], v31 offset:52224
    v_mfma_f32_16x16x32_bf16 v[232:235], a[120:123], a[176:179], v[232:235]
    s_lshl_b32 s60, s60, 8
    s_add_u32 s59, s60, 10485760
    v_mfma_f32_16x16x32_bf16 v[236:239], a[124:127], a[176:179], v[236:239]
    buffer_load_dwordx4 v24, s[36:39], s5 offen offset:2048 lds
    v_mfma_f32_16x16x32_bf16 v[236:239], a[108:111], a[172:175], v[236:239]
    s_add_u32 s60, s60, 10485888
    s_waitcnt lgkmcnt(10)
    v_mfma_f32_16x16x32_bf16 v[252:255], a[108:111], a[180:183], v[252:255]
    ds_read_b128 a[172:175], v26 offset:53248
    ds_read_b128 v[64:67], v15 offset:16384
    v_mfma_f32_16x16x32_bf16 v[252:255], a[124:127], a[184:187], v[252:255]
    ds_read_b128 v[68:71], v15 offset:16896
    ds_read_b128 v[72:75], v15 offset:17408
    v_mfma_f32_16x16x32_bf16 v[248:251], a[120:123], a[184:187], v[248:251]
    buffer_load_dwordx4 v25, s[36:39], s5 offen offset:3072 lds
    v_mfma_f32_16x16x32_bf16 v[248:251], a[104:107], a[180:183], v[248:251]
    ds_read_b128 v[76:79], v15 offset:17920
    ds_read_b128 v[80:83], v15 offset:16640
    v_mfma_f32_16x16x32_bf16 v[244:247], a[100:103], a[180:183], v[244:247]
    ds_read_b128 a[176:179], v27 offset:53248
    ds_read_b128 v[84:87], v15 offset:17152
    v_mfma_f32_16x16x32_bf16 v[244:247], a[116:119], a[184:187], v[244:247]
    ds_read_b128 v[88:91], v15 offset:17664
    ds_read_b128 v[92:95], v15 offset:18176
    v_mfma_f32_16x16x32_bf16 v[240:243], a[112:115], a[184:187], v[240:243]
    s_waitcnt vmcnt(20)
    ds_read_b64_tr_b16 a[0:1], v42 offset:0
    ds_read_b64_tr_b16 a[2:3], v42 offset:2048
    v_mfma_f32_16x16x32_bf16 v[240:243], a[96:99], a[180:183], v[240:243]
    ds_read_b64_tr_b16 a[4:5], v43 offset:0
    s_waitcnt lgkmcnt(14)
    v_mfma_f32_16x16x32_bf16 v[128:131], a[128:131], a[188:191], v[128:131]
    ds_read_b128 a[180:183], v26 offset:57344
    ds_read_b64_tr_b16 a[6:7], v43 offset:2048
    v_mfma_f32_16x16x32_bf16 v[128:131], a[144:147], a[192:195], v[128:131]
    ds_read_b64_tr_b16 a[8:9], v44 offset:0
    ds_read_b64_tr_b16 a[10:11], v44 offset:2048
    v_mfma_f32_16x16x32_bf16 v[132:135], a[148:151], a[192:195], v[132:135]
    ds_read_b64_tr_b16 a[12:13], v45 offset:0
    ds_read_b64_tr_b16 a[14:15], v45 offset:2048
    v_mfma_f32_16x16x32_bf16 v[132:135], a[132:135], a[188:191], v[132:135]
    s_waitcnt vmcnt(16)
    ds_read_b64_tr_b16 a[16:17], v42 offset:16384
    ds_read_b64_tr_b16 a[18:19], v42 offset:18432
    v_mfma_f32_16x16x32_bf16 v[136:139], a[136:139], a[188:191], v[136:139]
    ds_read_b128 a[184:187], v27 offset:57344
    ds_read_b64_tr_b16 a[20:21], v43 offset:16384
    v_mfma_f32_16x16x32_bf16 v[136:139], a[152:155], a[192:195], v[136:139]
    s_add_u32 m0, s64, 131072
    s_lshl_b32 s5, s11, 5
    s_waitcnt lgkmcnt(14)
    v_mfma_f32_16x16x32_bf16 v[140:143], a[156:159], a[192:195], v[140:143]
    s_waitcnt lgkmcnt(4)
    buffer_load_dwordx4 v22, s[36:39], s5 offen offset:0 lds
    v_mfma_f32_16x16x32_bf16 v[140:143], a[140:143], a[188:191], v[140:143]
    ds_read_b64_tr_b16 a[22:23], v43 offset:18432
    v_mfma_f32_16x16x32_bf16 v[172:175], a[140:143], a[172:175], v[172:175]
    ds_read_b128 a[188:191], v26 offset:61440
    ds_read_b64_tr_b16 a[24:25], v44 offset:16384
    v_mfma_f32_16x16x32_bf16 v[172:175], a[156:159], a[176:179], v[172:175]
    ds_read_b64_tr_b16 a[26:27], v44 offset:18432
    ds_read_b64_tr_b16 a[28:29], v45 offset:16384
    v_mfma_f32_16x16x32_bf16 v[168:171], a[152:155], a[176:179], v[168:171]
    buffer_load_dwordx4 v23, s[36:39], s5 offen offset:1024 lds
    v_mfma_f32_16x16x32_bf16 v[168:171], a[136:139], a[172:175], v[168:171]
    s_barrier
    v_mfma_f32_16x16x32_bf16 v[164:167], a[132:135], a[172:175], v[164:167]
    ds_read_b128 a[192:195], v27 offset:61440
    ds_read_b64_tr_b16 a[30:31], v45 offset:18432
    v_mfma_f32_16x16x32_bf16 v[164:167], a[148:151], a[176:179], v[164:167]
    s_waitcnt vmcnt(14)
    ds_read_b64_tr_b16 a[32:33], v34 offset:0
    ds_read_b64_tr_b16 a[34:35], v34 offset:2048
    v_mfma_f32_16x16x32_bf16 v[160:163], a[144:147], a[176:179], v[160:163]
    buffer_load_dwordx4 v24, s[36:39], s5 offen offset:2048 lds
    v_mfma_f32_16x16x32_bf16 v[160:163], a[128:131], a[172:175], v[160:163]
    ds_read_b64_tr_b16 a[36:37], v35 offset:0
    s_waitcnt lgkmcnt(11)
    v_mfma_f32_16x16x32_bf16 v[192:195], a[128:131], a[180:183], v[192:195]
    ds_read_b128 a[172:175], v26 offset:51200
    ds_read_b64_tr_b16 a[38:39], v35 offset:2048
    v_mfma_f32_16x16x32_bf16 v[192:195], a[144:147], a[184:187], v[192:195]
    ds_read_b64_tr_b16 a[40:41], v36 offset:0
    ds_read_b64_tr_b16 a[42:43], v36 offset:2048
    v_mfma_f32_16x16x32_bf16 v[196:199], a[148:151], a[184:187], v[196:199]
    buffer_load_dwordx4 v25, s[36:39], s5 offen offset:3072 lds
    v_mfma_f32_16x16x32_bf16 v[196:199], a[132:135], a[180:183], v[196:199]
    ds_read_b64_tr_b16 a[44:45], v37 offset:0
    ds_read_b64_tr_b16 a[46:47], v37 offset:2048
    v_mfma_f32_16x16x32_bf16 v[200:203], a[136:139], a[180:183], v[200:203]
    ds_read_b128 a[176:179], v27 offset:51200
    v_fmac_f32 v128, v104, v64
    v_mfma_f32_16x16x32_bf16 v[200:203], a[152:155], a[184:187], v[200:203]
    s_add_u32 m0, s64, 114688
    s_add_u32 s5, s5, 32768
    v_mfma_f32_16x16x32_bf16 v[204:207], a[156:159], a[184:187], v[204:207]
    buffer_load_dwordx4 v22, s[36:39], s5 offen offset:0 lds
    v_mfma_f32_16x16x32_bf16 v[204:207], a[140:143], a[180:183], v[204:207]
    v_fmac_f32 v129, v105, v64
    s_waitcnt lgkmcnt(11)
    v_mfma_f32_16x16x32_bf16 v[236:239], a[140:143], a[188:191], v[236:239]
    ds_read_b128 a[180:183], v26 offset:55296
    v_fmac_f32_e64 v130, v106, v64
    v_mfma_f32_16x16x32_bf16 v[236:239], a[156:159], a[192:195], v[236:239]
    v_fmac_f32 v131, v107, v64
    v_fmac_f32 v132, v108, v64
    v_mfma_f32_16x16x32_bf16 v[232:235], a[152:155], a[192:195], v[232:235]
    buffer_load_dwordx4 v23, s[36:39], s5 offen offset:1024 lds
    v_mfma_f32_16x16x32_bf16 v[232:235], a[136:139], a[188:191], v[232:235]
Lpad_g1:
    s_cbranch_execz Lret_g
    v_fmac_f32 v133, v109, v64
    v_fmac_f32_e64 v134, v110, v64
    v_mfma_f32_16x16x32_bf16 v[228:231], a[132:135], a[188:191], v[228:231]
    ds_read_b128 a[184:187], v27 offset:55296
    v_fmac_f32_e64 v135, v111, v64
    v_mfma_f32_16x16x32_bf16 v[228:231], a[148:151], a[192:195], v[228:231]
    v_mul_f32 v128, v128, v66
    v_mul_f32 v129, v129, v66
    v_mfma_f32_16x16x32_bf16 v[224:227], a[144:147], a[192:195], v[224:227]
    buffer_load_dwordx4 v24, s[36:39], s5 offen offset:2048 lds
    v_mfma_f32_16x16x32_bf16 v[224:227], a[128:131], a[188:191], v[224:227]
    v_mul_f32 v130, v130, v66
    s_waitcnt lgkmcnt(2)
    v_mfma_f32_16x16x32_bf16 v[144:147], a[128:131], a[172:175], v[144:147]
    ds_read_b128 a[188:191], v26 offset:59392
    v_mul_f32_e64 v131, v131, v66
    v_mfma_f32_16x16x32_bf16 v[144:147], a[144:147], a[176:179], v[144:147]
    v_mul_f32 v132, v132, v66
    v_mul_f32 v133, v133, v66
    v_mfma_f32_16x16x32_bf16 v[148:151], a[148:151], a[176:179], v[148:151]
    buffer_load_dwordx4 v25, s[36:39], s5 offen offset:3072 lds
    v_mfma_f32_16x16x32_bf16 v[148:151], a[132:135], a[172:175], v[148:151]
    v_mul_f32 v134, v134, v66
    v_mul_f32 v135, v135, v66
    v_mfma_f32_16x16x32_bf16 v[152:155], a[136:139], a[172:175], v[152:155]
    ds_read_b128 a[192:195], v27 offset:59392
    v_mfma_f32_16x16x32_bf16 v[152:155], a[152:155], a[176:179], v[152:155]
    s_add_u32 m0, s64, 32768
    s_lshl_b32 s5, s12, 5
    v_mfma_f32_16x16x32_bf16 v[156:159], a[156:159], a[176:179], v[156:159]
    buffer_load_dwordx4 v22, s[36:39], s5 offen offset:0 lds
    v_mfma_f32_16x16x32_bf16 v[156:159], a[140:143], a[172:175], v[156:159]
    s_waitcnt lgkmcnt(2)
    v_mfma_f32_16x16x32_bf16 v[188:191], a[140:143], a[180:183], v[188:191]
    ds_read_b128 a[172:175], v26 offset:63488
    v_mfma_f32_16x16x32_bf16 v[188:191], a[156:159], a[184:187], v[188:191]
    v_exp_f32_e64 v128, v128
    v_mfma_f32_16x16x32_bf16 v[184:187], a[152:155], a[184:187], v[184:187]
    buffer_load_dwordx4 v23, s[36:39], s5 offen offset:1024 lds
    v_mfma_f32_16x16x32_bf16 v[184:187], a[136:139], a[180:183], v[184:187]
    v_exp_f32_e64 v129, v129
    v_mfma_f32_16x16x32_bf16 v[180:183], a[132:135], a[180:183], v[180:183]
    ds_read_b128 a[176:179], v27 offset:63488
    v_mfma_f32_16x16x32_bf16 v[180:183], a[148:151], a[184:187], v[180:183]
    v_exp_f32_e64 v130, v130
    v_mfma_f32_16x16x32_bf16 v[176:179], a[144:147], a[184:187], v[176:179]
    buffer_load_dwordx4 v24, s[36:39], s5 offen offset:2048 lds
    v_mfma_f32_16x16x32_bf16 v[176:179], a[128:131], a[180:183], v[176:179]
    s_waitcnt lgkmcnt(2)
    v_mfma_f32_16x16x32_bf16 v[208:211], a[128:131], a[188:191], v[208:211]
    v_exp_f32 v131, v131
    v_mfma_f32_16x16x32_bf16 v[208:211], a[144:147], a[192:195], v[208:211]
    v_exp_f32_e64 v132, v132
    v_mfma_f32_16x16x32_bf16 v[212:215], a[148:151], a[192:195], v[212:215]
    buffer_load_dwordx4 v25, s[36:39], s5 offen offset:3072 lds
    v_mfma_f32_16x16x32_bf16 v[212:215], a[132:135], a[188:191], v[212:215]
    v_exp_f32_e64 v133, v133
    s_waitcnt lgkmcnt(0)
    s_barrier
    v_mfma_f32_16x16x32_bf16 v[216:219], a[136:139], a[188:191], v[216:219]
    v_exp_f32_e64 v134, v134
    v_mfma_f32_16x16x32_bf16 v[216:219], a[152:155], a[192:195], v[216:219]
    s_add_u32 m0, s64, 147456
    s_add_u32 s5, s5, 32768
    v_mfma_f32_16x16x32_bf16 v[220:223], a[156:159], a[192:195], v[220:223]
    buffer_load_dwordx4 v22, s[36:39], s5 offen offset:0 lds
    v_mfma_f32_16x16x32_bf16 v[220:223], a[140:143], a[188:191], v[220:223]
    v_mfma_f32_16x16x32_bf16 v[252:255], a[140:143], a[172:175], v[252:255]
    v_exp_f32_e64 v135, v135
    v_mfma_f32_16x16x32_bf16 v[252:255], a[156:159], a[176:179], v[252:255]
    v_mfma_f32_16x16x32_bf16 v[248:251], a[152:155], a[176:179], v[248:251]
    buffer_load_dwordx4 v23, s[36:39], s5 offen offset:1024 lds
    v_mfma_f32_16x16x32_bf16 v[248:251], a[136:139], a[172:175], v[248:251]
    v_mfma_f32_16x16x32_bf16 v[244:247], a[132:135], a[172:175], v[244:247]
    v_mfma_f32_16x16x32_bf16 v[244:247], a[148:151], a[176:179], v[244:247]
    v_mfma_f32_16x16x32_bf16 v[240:243], a[144:147], a[176:179], v[240:243]
    buffer_load_dwordx4 v24, s[36:39], s5 offen offset:2048 lds
    v_mfma_f32_16x16x32_bf16 v[240:243], a[128:131], a[172:175], v[240:243]
    v_pk_fma_f32 v[136:137], v[112:113], v[64:65], v[136:137] op_sel_hi:[1,0,1]
    v_pk_fma_f32 v[138:139], v[114:115], v[64:65], v[138:139] op_sel_hi:[1,0,1]
    v_pk_fma_f32 v[140:141], v[116:117], v[64:65], v[140:141] op_sel_hi:[1,0,1]
    v_pk_fma_f32 v[142:143], v[118:119], v[64:65], v[142:143] op_sel_hi:[1,0,1]
    v_pk_fma_f32 v[128:129], v[128:129], v[64:65], v[64:65] op_sel:[0,1,1] op_sel_hi:[1,1,1]
    v_pk_fma_f32 v[130:131], v[130:131], v[64:65], v[64:65] op_sel:[0,1,1] op_sel_hi:[1,1,1]
    v_pk_fma_f32 v[132:133], v[132:133], v[64:65], v[64:65] op_sel:[0,1,1] op_sel_hi:[1,1,1]
    v_pk_fma_f32 v[134:135], v[134:135], v[64:65], v[64:65] op_sel:[0,1,1] op_sel_hi:[1,1,1]
    buffer_load_dwordx4 v25, s[36:39], s5 offen offset:3072 lds
    v_rcp_f32 v128, v128
    v_rcp_f32 v129, v129
    v_rcp_f32 v130, v130
    v_rcp_f32 v131, v131
    v_rcp_f32 v132, v132
    v_rcp_f32 v133, v133
    v_rcp_f32 v134, v134
    v_rcp_f32 v135, v135
    v_pk_mul_f32 v[136:137], v[136:137], v[128:129]
    v_pk_mul_f32 v[138:139], v[138:139], v[130:131]
    v_pk_mul_f32 v[140:141], v[140:141], v[132:133]
    v_pk_mul_f32 v[142:143], v[142:143], v[134:135]
    v_cvt_pk_bf16_f32 v96, v136, v137
    v_cvt_pk_bf16_f32 v97, v138, v139
    v_cvt_pk_bf16_f32 v98, v140, v141
    v_cvt_pk_bf16_f32 v99, v142, v143
    buffer_store_dwordx4 v[96:99], v16, s[32:35], s52 offen sc1
    v_pk_fma_f32 v[160:161], v[104:105], v[68:69], v[160:161] op_sel_hi:[1,0,1]
    v_pk_fma_f32 v[162:163], v[106:107], v[68:69], v[162:163] op_sel_hi:[1,0,1]
    v_pk_fma_f32 v[164:165], v[108:109], v[68:69], v[164:165] op_sel_hi:[1,0,1]
    v_pk_fma_f32 v[166:167], v[110:111], v[68:69], v[166:167] op_sel_hi:[1,0,1]
    v_pk_mul_f32 v[160:161], v[160:161], v[70:71] op_sel_hi:[1,0]
    v_pk_mul_f32 v[162:163], v[162:163], v[70:71] op_sel_hi:[1,0]
    v_pk_mul_f32 v[164:165], v[164:165], v[70:71] op_sel_hi:[1,0]
    v_pk_mul_f32 v[166:167], v[166:167], v[70:71] op_sel_hi:[1,0]
    v_exp_f32 v160, v160
    v_exp_f32 v161, v161
    v_exp_f32 v162, v162
    v_exp_f32 v163, v163
    v_exp_f32 v164, v164
    v_exp_f32 v165, v165
    v_exp_f32 v166, v166
    v_exp_f32 v167, v167
    v_pk_fma_f32 v[168:169], v[112:113], v[68:69], v[168:169] op_sel_hi:[1,0,1]
    v_pk_fma_f32 v[170:171], v[114:115], v[68:69], v[170:171] op_sel_hi:[1,0,1]
    v_pk_fma_f32 v[172:173], v[116:117], v[68:69], v[172:173] op_sel_hi:[1,0,1]
    v_pk_fma_f32 v[174:175], v[118:119], v[68:69], v[174:175] op_sel_hi:[1,0,1]
    v_pk_fma_f32 v[160:161], v[160:161], v[68:69], v[68:69] op_sel:[0,1,1] op_sel_hi:[1,1,1]
    v_pk_fma_f32 v[162:163], v[162:163], v[68:69], v[68:69] op_sel:[0,1,1] op_sel_hi:[1,1,1]
    v_pk_fma_f32 v[164:165], v[164:165], v[68:69], v[68:69] op_sel:[0,1,1] op_sel_hi:[1,1,1]
    v_pk_fma_f32 v[166:167], v[166:167], v[68:69], v[68:69] op_sel:[0,1,1] op_sel_hi:[1,1,1]
    s_add_u32 m0, s64, 49152
    s_lshl_b32 s5, s13, 5
    buffer_load_dwordx4 v22, s[36:39], s5 offen offset:0 lds
    v_rcp_f32 v160, v160
    v_rcp_f32 v161, v161
    v_rcp_f32 v162, v162
    v_rcp_f32 v163, v163
    v_rcp_f32 v164, v164
    v_rcp_f32 v165, v165
    v_rcp_f32 v166, v166
    v_rcp_f32_e64 v167, v167
    s_add_u32 s52, s52, 114688
    v_pk_mul_f32 v[168:169], v[168:169], v[160:161]
    v_pk_mul_f32 v[170:171], v[170:171], v[162:163]
    v_pk_mul_f32 v[172:173], v[172:173], v[164:165]
    v_pk_mul_f32 v[174:175], v[174:175], v[166:167]
    v_cvt_pk_bf16_f32 v100, v168, v169
    v_cvt_pk_bf16_f32 v101, v170, v171
    v_cvt_pk_bf16_f32 v102, v172, v173
    v_cvt_pk_bf16_f32 v103, v174, v175
    buffer_store_dwordx4 v[100:103], v16, s[32:35], s52 offen sc1
    v_pk_fma_f32 v[192:193], v[104:105], v[72:73], v[192:193] op_sel_hi:[1,0,1]
    v_pk_fma_f32 v[194:195], v[106:107], v[72:73], v[194:195] op_sel_hi:[1,0,1]
    v_pk_fma_f32 v[196:197], v[108:109], v[72:73], v[196:197] op_sel_hi:[1,0,1]
    v_pk_fma_f32 v[198:199], v[110:111], v[72:73], v[198:199] op_sel_hi:[1,0,1]
    v_pk_mul_f32 v[192:193], v[192:193], v[74:75] op_sel_hi:[1,0]
    v_pk_mul_f32 v[194:195], v[194:195], v[74:75] op_sel_hi:[1,0]
    v_pk_mul_f32 v[196:197], v[196:197], v[74:75] op_sel_hi:[1,0]
    v_pk_mul_f32 v[198:199], v[198:199], v[74:75] op_sel_hi:[1,0]
    v_exp_f32 v192, v192
    v_exp_f32 v193, v193
    v_exp_f32 v194, v194
    v_exp_f32 v195, v195
    v_exp_f32 v196, v196
    v_exp_f32 v197, v197
    v_exp_f32 v198, v198
    v_exp_f32 v199, v199
    v_pk_fma_f32 v[200:201], v[112:113], v[72:73], v[200:201] op_sel_hi:[1,0,1]
    v_pk_fma_f32 v[202:203], v[114:115], v[72:73], v[202:203] op_sel_hi:[1,0,1]
    v_pk_fma_f32 v[204:205], v[116:117], v[72:73], v[204:205] op_sel_hi:[1,0,1]
    v_pk_fma_f32 v[206:207], v[118:119], v[72:73], v[206:207] op_sel_hi:[1,0,1]
    v_pk_fma_f32 v[192:193], v[192:193], v[72:73], v[72:73] op_sel:[0,1,1] op_sel_hi:[1,1,1]
    v_pk_fma_f32 v[194:195], v[194:195], v[72:73], v[72:73] op_sel:[0,1,1] op_sel_hi:[1,1,1]
    v_pk_fma_f32 v[196:197], v[196:197], v[72:73], v[72:73] op_sel:[0,1,1] op_sel_hi:[1,1,1]
    v_pk_fma_f32 v[198:199], v[198:199], v[72:73], v[72:73] op_sel:[0,1,1] op_sel_hi:[1,1,1]
    buffer_load_dwordx4 v23, s[36:39], s5 offen offset:1024 lds
    v_rcp_f32 v192, v192
    v_rcp_f32 v193, v193
    v_rcp_f32 v194, v194
    v_rcp_f32 v195, v195
    v_rcp_f32 v196, v196
    v_rcp_f32 v197, v197
    v_rcp_f32 v198, v198
    v_rcp_f32 v199, v199
    s_add_u32 s52, s52, 114688
    v_pk_mul_f32 v[200:201], v[200:201], v[192:193]
    v_pk_mul_f32 v[202:203], v[202:203], v[194:195]
    v_pk_mul_f32 v[204:205], v[204:205], v[196:197]
    v_pk_mul_f32 v[206:207], v[206:207], v[198:199]
    v_cvt_pk_bf16_f32 v96, v200, v201
    v_cvt_pk_bf16_f32 v97, v202, v203
    v_cvt_pk_bf16_f32 v98, v204, v205
    v_cvt_pk_bf16_f32 v99, v206, v207
    buffer_store_dwordx4 v[96:99], v16, s[32:35], s52 offen sc1
    v_pk_fma_f32 v[224:225], v[104:105], v[76:77], v[224:225] op_sel_hi:[1,0,1]
    v_pk_fma_f32 v[226:227], v[106:107], v[76:77], v[226:227] op_sel_hi:[1,0,1]
    v_pk_fma_f32 v[228:229], v[108:109], v[76:77], v[228:229] op_sel_hi:[1,0,1]
    v_pk_fma_f32 v[230:231], v[110:111], v[76:77], v[230:231] op_sel_hi:[1,0,1]
    v_pk_mul_f32 v[224:225], v[224:225], v[78:79] op_sel_hi:[1,0]
    v_pk_mul_f32 v[226:227], v[226:227], v[78:79] op_sel_hi:[1,0]
    v_pk_mul_f32 v[228:229], v[228:229], v[78:79] op_sel_hi:[1,0]
    v_pk_mul_f32 v[230:231], v[230:231], v[78:79] op_sel_hi:[1,0]
    v_exp_f32 v224, v224
    v_exp_f32 v225, v225
    v_exp_f32 v226, v226
    v_exp_f32 v227, v227
    v_exp_f32 v228, v228
    v_exp_f32 v229, v229
    v_exp_f32 v230, v230
    v_exp_f32 v231, v231
    v_pk_fma_f32 v[232:233], v[112:113], v[76:77], v[232:233] op_sel_hi:[1,0,1]
    v_pk_fma_f32 v[234:235], v[114:115], v[76:77], v[234:235] op_sel_hi:[1,0,1]
    v_pk_fma_f32 v[236:237], v[116:117], v[76:77], v[236:237] op_sel_hi:[1,0,1]
    v_pk_fma_f32 v[238:239], v[118:119], v[76:77], v[238:239] op_sel_hi:[1,0,1]
    v_pk_fma_f32 v[224:225], v[224:225], v[76:77], v[76:77] op_sel:[0,1,1] op_sel_hi:[1,1,1]
    v_pk_fma_f32 v[226:227], v[226:227], v[76:77], v[76:77] op_sel:[0,1,1] op_sel_hi:[1,1,1]
    v_pk_fma_f32 v[228:229], v[228:229], v[76:77], v[76:77] op_sel:[0,1,1] op_sel_hi:[1,1,1]
    v_pk_fma_f32 v[230:231], v[230:231], v[76:77], v[76:77] op_sel:[0,1,1] op_sel_hi:[1,1,1]
    buffer_load_dwordx4 v24, s[36:39], s5 offen offset:2048 lds
    v_rcp_f32 v224, v224
    v_rcp_f32 v225, v225
    v_rcp_f32 v226, v226
    v_rcp_f32 v227, v227
    v_rcp_f32 v228, v228
    v_rcp_f32 v229, v229
    v_rcp_f32 v230, v230
    v_rcp_f32 v231, v231
    s_add_u32 s52, s52, 114688
    v_pk_mul_f32 v[232:233], v[232:233], v[224:225]
    v_pk_mul_f32 v[234:235], v[234:235], v[226:227]
    v_pk_mul_f32 v[236:237], v[236:237], v[228:229]
    v_pk_mul_f32 v[238:239], v[238:239], v[230:231]
    v_cvt_pk_bf16_f32 v100, v232, v233
    v_cvt_pk_bf16_f32 v101, v234, v235
    v_cvt_pk_bf16_f32 v102, v236, v237
    v_cvt_pk_bf16_f32 v103, v238, v239
    buffer_store_dwordx4 v[100:103], v16, s[32:35], s52 offen sc1
    v_pk_fma_f32 v[144:145], v[104:105], v[80:81], v[144:145] op_sel_hi:[1,0,1]
    v_pk_fma_f32 v[146:147], v[106:107], v[80:81], v[146:147] op_sel_hi:[1,0,1]
    v_pk_fma_f32 v[148:149], v[108:109], v[80:81], v[148:149] op_sel_hi:[1,0,1]
    v_pk_fma_f32 v[150:151], v[110:111], v[80:81], v[150:151] op_sel_hi:[1,0,1]
    v_pk_mul_f32 v[144:145], v[144:145], v[82:83] op_sel_hi:[1,0]
    v_pk_mul_f32 v[146:147], v[146:147], v[82:83] op_sel_hi:[1,0]
    v_pk_mul_f32 v[148:149], v[148:149], v[82:83] op_sel_hi:[1,0]
    v_pk_mul_f32 v[150:151], v[150:151], v[82:83] op_sel_hi:[1,0]
    v_exp_f32 v144, v144
    v_exp_f32 v145, v145
    v_exp_f32 v146, v146
    v_exp_f32 v147, v147
    v_exp_f32 v148, v148
    v_exp_f32 v149, v149
    v_exp_f32 v150, v150
    v_exp_f32 v151, v151
    v_pk_fma_f32 v[152:153], v[112:113], v[80:81], v[152:153] op_sel_hi:[1,0,1]
    v_pk_fma_f32 v[154:155], v[114:115], v[80:81], v[154:155] op_sel_hi:[1,0,1]
    v_pk_fma_f32 v[156:157], v[116:117], v[80:81], v[156:157] op_sel_hi:[1,0,1]
    v_pk_fma_f32 v[158:159], v[118:119], v[80:81], v[158:159] op_sel_hi:[1,0,1]
    v_pk_fma_f32 v[144:145], v[144:145], v[80:81], v[80:81] op_sel:[0,1,1] op_sel_hi:[1,1,1]
    v_pk_fma_f32 v[146:147], v[146:147], v[80:81], v[80:81] op_sel:[0,1,1] op_sel_hi:[1,1,1]
    v_pk_fma_f32 v[148:149], v[148:149], v[80:81], v[80:81] op_sel:[0,1,1] op_sel_hi:[1,1,1]
    v_pk_fma_f32 v[150:151], v[150:151], v[80:81], v[80:81] op_sel:[0,1,1] op_sel_hi:[1,1,1]
    buffer_load_dwordx4 v25, s[36:39], s5 offen offset:3072 lds
    v_rcp_f32 v144, v144
    v_rcp_f32 v145, v145
    v_rcp_f32 v146, v146
    v_rcp_f32 v147, v147
    v_rcp_f32 v148, v148
    v_rcp_f32 v149, v149
    v_rcp_f32 v150, v150
    v_rcp_f32 v151, v151
    s_sub_u32 s52, s52, 286720
    v_pk_mul_f32 v[152:153], v[152:153], v[144:145]
    v_pk_mul_f32 v[154:155], v[154:155], v[146:147]
    v_pk_mul_f32 v[156:157], v[156:157], v[148:149]
    v_pk_mul_f32 v[158:159], v[158:159], v[150:151]
    v_cvt_pk_bf16_f32 v96, v152, v153
    v_cvt_pk_bf16_f32 v97, v154, v155
    v_cvt_pk_bf16_f32 v98, v156, v157
    v_cvt_pk_bf16_f32 v99, v158, v159
    buffer_store_dwordx4 v[96:99], v16, s[32:35], s52 offen sc1
    v_pk_fma_f32 v[176:177], v[104:105], v[84:85], v[176:177] op_sel_hi:[1,0,1]
    v_pk_fma_f32 v[178:179], v[106:107], v[84:85], v[178:179] op_sel_hi:[1,0,1]
    v_pk_fma_f32 v[180:181], v[108:109], v[84:85], v[180:181] op_sel_hi:[1,0,1]
    v_pk_fma_f32 v[182:183], v[110:111], v[84:85], v[182:183] op_sel_hi:[1,0,1]
    v_pk_mul_f32 v[176:177], v[176:177], v[86:87] op_sel_hi:[1,0]
    v_pk_mul_f32 v[178:179], v[178:179], v[86:87] op_sel_hi:[1,0]
    v_pk_mul_f32 v[180:181], v[180:181], v[86:87] op_sel_hi:[1,0]
    v_pk_mul_f32 v[182:183], v[182:183], v[86:87] op_sel_hi:[1,0]
    v_exp_f32 v176, v176
    v_exp_f32 v177, v177
    v_exp_f32 v178, v178
    v_exp_f32 v179, v179
    v_exp_f32 v180, v180
    v_exp_f32 v181, v181
    v_exp_f32 v182, v182
    v_exp_f32 v183, v183
    v_pk_fma_f32 v[184:185], v[112:113], v[84:85], v[184:185] op_sel_hi:[1,0,1]
    v_pk_fma_f32 v[186:187], v[114:115], v[84:85], v[186:187] op_sel_hi:[1,0,1]
    v_pk_fma_f32 v[188:189], v[116:117], v[84:85], v[188:189] op_sel_hi:[1,0,1]
    v_pk_fma_f32 v[190:191], v[118:119], v[84:85], v[190:191] op_sel_hi:[1,0,1]
    v_pk_fma_f32 v[176:177], v[176:177], v[84:85], v[84:85] op_sel:[0,1,1] op_sel_hi:[1,1,1]
    v_pk_fma_f32 v[178:179], v[178:179], v[84:85], v[84:85] op_sel:[0,1,1] op_sel_hi:[1,1,1]
    v_pk_fma_f32 v[180:181], v[180:181], v[84:85], v[84:85] op_sel:[0,1,1] op_sel_hi:[1,1,1]
    v_pk_fma_f32 v[182:183], v[182:183], v[84:85], v[84:85] op_sel:[0,1,1] op_sel_hi:[1,1,1]
    s_add_u32 m0, s64, 0
    s_add_u32 s5, s5, 32768
    buffer_load_dwordx4 v22, s[36:39], s5 offen offset:0 lds
    v_rcp_f32 v176, v176
    v_rcp_f32 v177, v177
    v_rcp_f32 v178, v178
    v_rcp_f32 v179, v179
    v_rcp_f32 v180, v180
    v_rcp_f32 v181, v181
    v_rcp_f32 v182, v182
    v_rcp_f32_e64 v183, v183
    s_add_u32 s52, s52, 114688
    v_pk_mul_f32 v[184:185], v[184:185], v[176:177]
    v_pk_mul_f32 v[186:187], v[186:187], v[178:179]
    v_pk_mul_f32 v[188:189], v[188:189], v[180:181]
    v_pk_mul_f32 v[190:191], v[190:191], v[182:183]
    v_cvt_pk_bf16_f32 v100, v184, v185
    v_cvt_pk_bf16_f32 v101, v186, v187
    v_cvt_pk_bf16_f32 v102, v188, v189
    v_cvt_pk_bf16_f32 v103, v190, v191
    buffer_store_dwordx4 v[100:103], v16, s[32:35], s52 offen sc1
    v_pk_fma_f32 v[208:209], v[104:105], v[88:89], v[208:209] op_sel_hi:[1,0,1]
    v_pk_fma_f32 v[210:211], v[106:107], v[88:89], v[210:211] op_sel_hi:[1,0,1]
    v_pk_fma_f32 v[212:213], v[108:109], v[88:89], v[212:213] op_sel_hi:[1,0,1]
    v_pk_fma_f32 v[214:215], v[110:111], v[88:89], v[214:215] op_sel_hi:[1,0,1]
    v_pk_mul_f32 v[208:209], v[208:209], v[90:91] op_sel_hi:[1,0]
    v_pk_mul_f32 v[210:211], v[210:211], v[90:91] op_sel_hi:[1,0]
    v_pk_mul_f32 v[212:213], v[212:213], v[90:91] op_sel_hi:[1,0]
    v_pk_mul_f32 v[214:215], v[214:215], v[90:91] op_sel_hi:[1,0]
    v_exp_f32 v208, v208
    v_exp_f32 v209, v209
    v_exp_f32 v210, v210
    v_exp_f32 v211, v211
    v_exp_f32 v212, v212
    v_exp_f32 v213, v213
    v_exp_f32 v214, v214
    v_exp_f32 v215, v215
    v_pk_fma_f32 v[216:217], v[112:113], v[88:89], v[216:217] op_sel_hi:[1,0,1]
    v_pk_fma_f32 v[218:219], v[114:115], v[88:89], v[218:219] op_sel_hi:[1,0,1]
    v_pk_fma_f32 v[220:221], v[116:117], v[88:89], v[220:221] op_sel_hi:[1,0,1]
    v_pk_fma_f32 v[222:223], v[118:119], v[88:89], v[222:223] op_sel_hi:[1,0,1]
    v_pk_fma_f32 v[208:209], v[208:209], v[88:89], v[88:89] op_sel:[0,1,1] op_sel_hi:[1,1,1]
    v_pk_fma_f32 v[210:211], v[210:211], v[88:89], v[88:89] op_sel:[0,1,1] op_sel_hi:[1,1,1]
    v_pk_fma_f32 v[212:213], v[212:213], v[88:89], v[88:89] op_sel:[0,1,1] op_sel_hi:[1,1,1]
    v_pk_fma_f32 v[214:215], v[214:215], v[88:89], v[88:89] op_sel:[0,1,1] op_sel_hi:[1,1,1]
    buffer_load_dwordx4 v23, s[36:39], s5 offen offset:1024 lds
    v_rcp_f32 v208, v208
    v_rcp_f32 v209, v209
    v_rcp_f32 v210, v210
    v_rcp_f32 v211, v211
    v_rcp_f32 v212, v212
    v_rcp_f32 v213, v213
    v_rcp_f32 v214, v214
    v_rcp_f32 v215, v215
    s_add_u32 s52, s52, 114688
    v_pk_mul_f32 v[216:217], v[216:217], v[208:209]
    v_pk_mul_f32 v[218:219], v[218:219], v[210:211]
    v_pk_mul_f32 v[220:221], v[220:221], v[212:213]
    v_pk_mul_f32 v[222:223], v[222:223], v[214:215]
    v_cvt_pk_bf16_f32 v96, v216, v217
    v_cvt_pk_bf16_f32 v97, v218, v219
    v_cvt_pk_bf16_f32 v98, v220, v221
    v_cvt_pk_bf16_f32 v99, v222, v223
    buffer_store_dwordx4 v[96:99], v16, s[32:35], s52 offen sc1
    v_pk_fma_f32 v[240:241], v[104:105], v[92:93], v[240:241] op_sel_hi:[1,0,1]
    v_pk_fma_f32 v[242:243], v[106:107], v[92:93], v[242:243] op_sel_hi:[1,0,1]
    v_pk_fma_f32 v[244:245], v[108:109], v[92:93], v[244:245] op_sel_hi:[1,0,1]
    v_pk_fma_f32 v[246:247], v[110:111], v[92:93], v[246:247] op_sel_hi:[1,0,1]
    v_pk_mul_f32 v[240:241], v[240:241], v[94:95] op_sel_hi:[1,0]
    v_pk_mul_f32 v[242:243], v[242:243], v[94:95] op_sel_hi:[1,0]
    v_pk_mul_f32 v[244:245], v[244:245], v[94:95] op_sel_hi:[1,0]
    v_pk_mul_f32 v[246:247], v[246:247], v[94:95] op_sel_hi:[1,0]
    v_exp_f32 v240, v240
    v_exp_f32 v241, v241
    v_exp_f32 v242, v242
    v_exp_f32 v243, v243
    v_exp_f32 v244, v244
    v_exp_f32 v245, v245
    v_exp_f32 v246, v246
    v_exp_f32 v247, v247
    v_pk_fma_f32 v[248:249], v[112:113], v[92:93], v[248:249] op_sel_hi:[1,0,1]
    v_pk_fma_f32 v[250:251], v[114:115], v[92:93], v[250:251] op_sel_hi:[1,0,1]
    v_pk_fma_f32 v[252:253], v[116:117], v[92:93], v[252:253] op_sel_hi:[1,0,1]
    v_pk_fma_f32 v[254:255], v[118:119], v[92:93], v[254:255] op_sel_hi:[1,0,1]
    v_pk_fma_f32 v[240:241], v[240:241], v[92:93], v[92:93] op_sel:[0,1,1] op_sel_hi:[1,1,1]
    v_pk_fma_f32 v[242:243], v[242:243], v[92:93], v[92:93] op_sel:[0,1,1] op_sel_hi:[1,1,1]
    v_pk_fma_f32 v[244:245], v[244:245], v[92:93], v[92:93] op_sel:[0,1,1] op_sel_hi:[1,1,1]
    v_pk_fma_f32 v[246:247], v[246:247], v[92:93], v[92:93] op_sel:[0,1,1] op_sel_hi:[1,1,1]
    buffer_load_dwordx4 v24, s[36:39], s5 offen offset:2048 lds
    v_rcp_f32 v240, v240
    v_rcp_f32 v241, v241
    v_rcp_f32 v242, v242
    v_rcp_f32 v243, v243
    v_rcp_f32 v244, v244
    v_rcp_f32 v245, v245
    v_rcp_f32 v246, v246
    v_rcp_f32 v247, v247
    s_add_u32 s52, s52, 114688
    v_pk_mul_f32 v[248:249], v[248:249], v[240:241]
    v_pk_mul_f32 v[250:251], v[250:251], v[242:243]
    v_pk_mul_f32 v[252:253], v[252:253], v[244:245]
    v_pk_mul_f32 v[254:255], v[254:255], v[246:247]
    v_cvt_pk_bf16_f32 v100, v248, v249
    v_cvt_pk_bf16_f32 v101, v250, v251
    v_cvt_pk_bf16_f32 v102, v252, v253
    v_cvt_pk_bf16_f32 v103, v254, v255
    buffer_store_dwordx4 v[100:103], v16, s[32:35], s52 offen sc1
    s_waitcnt vmcnt(8)
    s_atomic_add s87, s[78:79], s59
    s_lshl_b32 s65, s6, 2
    s_add_u32 s65, s65, s44
    s_lshl_b32 s65, s65, 7
    s_add_u32 s65, s65, 10502148
    s_mov_b32 s86, 1048576
    s_lshr_b32 s48, s6, 1
    s_lshl_b32 s48, s48, 2
    s_add_u32 s48, s48, s44
    s_lshl_b32 s48, s48, 8
    s_add_u32 s63, s48, 10485760
    s_add_u32 s61, s48, 10485888
    buffer_load_dwordx4 v[48:51], v13, s[20:23], 0 offen
    buffer_load_dwordx4 v[52:55], v13, s[20:23], s86 offen
    ds_read_b64_tr_b16 a[48:49], v38 offset:0
    ds_read_b64_tr_b16 a[50:51], v38 offset:2048
    ds_read_b64_tr_b16 a[52:53], v39 offset:0
    ds_read_b64_tr_b16 a[54:55], v39 offset:2048
    ds_read_b64_tr_b16 a[56:57], v40 offset:0
    ds_read_b64_tr_b16 a[58:59], v40 offset:2048
    ds_read_b64_tr_b16 a[60:61], v41 offset:0
    ds_read_b64_tr_b16 a[62:63], v41 offset:2048
    ds_read_b64_tr_b16 a[64:65], v38 offset:16384
    ds_read_b64_tr_b16 a[66:67], v38 offset:18432
    ds_read_b64_tr_b16 a[68:69], v39 offset:16384
    ds_read_b64_tr_b16 a[70:71], v39 offset:18432
    ds_read_b64_tr_b16 a[72:73], v40 offset:16384
    ds_read_b64_tr_b16 a[74:75], v40 offset:18432
    ds_read_b64_tr_b16 a[76:77], v41 offset:16384
    ds_read_b64_tr_b16 a[78:79], v41 offset:18432
    ds_read_b64_tr_b16 a[80:81], v38 offset:32768
    ds_read_b64_tr_b16 a[82:83], v38 offset:34816
    ds_read_b64_tr_b16 a[84:85], v39 offset:32768
    ds_read_b64_tr_b16 a[86:87], v39 offset:34816
    ds_read_b64_tr_b16 a[88:89], v40 offset:32768
    ds_read_b64_tr_b16 a[90:91], v40 offset:34816
    ds_read_b64_tr_b16 a[92:93], v41 offset:32768
    ds_read_b64_tr_b16 a[94:95], v41 offset:34816
    s_waitcnt lgkmcnt(1)
    s_load_dword s17, s[78:79], s65 glc
    s_lshl_b32 s49, s7, 6
    s_sub_u32 s50, s49, 256
    s_sub_u32 s49, 193, s49
    s_cmp_ge_u32 s7, 4
    s_cselect_b32 s49, s50, s49
    s_cselect_b32 s51, 0, 63
    v_and_b32 v5, 31, v1
    v_lshrrev_b32_e64 v6, 5, v1
    v_lshl_add_u32 v5, v5, 1, s49
    v_add_u32_e64 v5, v5, v6
    s_mul_i32 s48, s47, 65536
    s_lshl_b32 s49, s44, 14
    s_add_u32 s48, s48, s49
    s_add_u32 s48, s48, 7929856
    v_cmp_gt_u32 vcc, 0x100, v5
    v_and_b32 v6, 1, v5
    v_lshrrev_b32 v5, 1, v5
    v_lshl_add_u32 v5, v6, 7, v5
    v_lshl_add_u32 v5, v5, 4, s48
    s_and_b32 s48, s44, 1
    s_lshl_b32 s48, s48, 5
    v_cndmask_b32 v26, v10, v5, vcc
    s_xor_b32 s48, s48, s51
    v_xor_b32_e64 v4, s48, v2
    v_add_u32 v27, 3072, v26
    v_add_u32 v28, 6144, v26
    v_add_u32 v29, 9216, v26
    v_and_b32 v6, 1, v4
    v_lshrrev_b32 v4, 1, v4
    v_lshl_add_u32 v4, v6, 5, v4
    v_lshl_add_u32 v4, v3, 6, v4
    v_lshlrev_b32_e64 v4, 4, v4
    v_add_u32 v14, 65536, v4
    v_xor_b32 v19, 0x80, v14
    s_waitcnt vmcnt(2)
    s_waitcnt lgkmcnt(0)
    s_atomic_add s87, s[78:79], s60
    s_mov_b32 s4, 0
    s_atomic_add s4, s[78:79], s63 glc
    buffer_load_dwordx4 v25, s[36:39], s5 offen offset:3072 lds
    s_add_u32 m0, s64, 98304
    s_cmp_ge_u32 s17, 8
    s_cbranch_scc0 Lgg_slow
Lgg_ok:
    buffer_load_dwordx4 v26, s[32:35], 0 offen offset:0 sc1 lds
    buffer_load_dwordx4 v27, s[32:35], 0 offen offset:1024 sc1 lds
    buffer_load_dwordx4 v28, s[32:35], 0 offen offset:2048 sc1 lds
    buffer_load_dwordx4 v29, s[32:35], 0 offen offset:3072 sc1 lds
    s_add_u32 m0, s64, 65536
    s_lshl_b32 s5, s14, 5
    buffer_load_dwordx4 v22, s[36:39], s5 offen offset:0 lds
    buffer_load_dwordx4 v23, s[36:39], s5 offen offset:1024 lds
    buffer_load_dwordx4 v24, s[36:39], s5 offen offset:2048 lds
    buffer_load_dwordx4 v25, s[36:39], s5 offen offset:3072 lds
    s_add_u32 m0, s64, 81920
    s_add_u32 s5, s5, 32768
    buffer_load_dwordx4 v22, s[36:39], s5 offen offset:0 lds
    buffer_load_dwordx4 v23, s[36:39], s5 offen offset:1024 lds
    buffer_load_dwordx4 v24, s[36:39], s5 offen offset:2048 lds
    buffer_load_dwordx4 v25, s[36:39], s5 offen offset:3072 lds
    v_lshlrev_b32_e64 v7, 4, v1
    s_mul_i32 s50, s6, 229376
    s_mul_i32 s49, s44, 14336
    s_add_u32 s50, s50, s49
    s_and_b32 s48, s44, 2
    s_mul_i32 s49, s48, 57344
    s_add_u32 s49, s49, s50
    v_add_u32 v31, s49, v7
    s_xor_b32 s48, s48, 2
    s_mul_i32 s49, s48, 57344
    s_add_u32 s49, s49, s50
    v_add_u32_e64 v30, s49, v7
    v_add_u32 v32, 57344, v30
    v_add_u32 v33, 57344, v31
    v_add_u32 v7, 65536, v7
    v_add_u32_e64 v15, s64, v7
    v_xor_b32 v18, 4096, v15
    v_xor_b32 v20, 8192, v15
    v_xor_b32 v21, 12288, v15
    ds_read_b64_tr_b16 a[96:97], v42 offset:0
    ds_read_b64_tr_b16 a[98:99], v42 offset:2048
    ds_read_b64_tr_b16 a[100:101], v43 offset:0
    ds_read_b64_tr_b16 a[102:103], v43 offset:2048
    ds_read_b64_tr_b16 a[104:105], v44 offset:0
    ds_read_b64_tr_b16 a[106:107], v44 offset:2048
    ds_read_b64_tr_b16 a[108:109], v45 offset:0
    ds_read_b64_tr_b16 a[110:111], v45 offset:2048
    ds_read_b64_tr_b16 a[112:113], v38 offset:49152
    ds_read_b64_tr_b16 a[114:115], v38 offset:51200
    ds_read_b64_tr_b16 a[116:117], v39 offset:49152
    ds_read_b64_tr_b16 a[118:119], v39 offset:51200
    ds_read_b64_tr_b16 a[120:121], v40 offset:49152
    ds_read_b64_tr_b16 a[122:123], v40 offset:51200
    ds_read_b64_tr_b16 a[124:125], v41 offset:49152
    ds_read_b64_tr_b16 a[126:127], v41 offset:51200
    ds_read_b64_tr_b16 a[128:129], v34 offset:32768
    ds_read_b64_tr_b16 a[130:131], v34 offset:34816
    ds_read_b64_tr_b16 a[132:133], v35 offset:32768
    ds_read_b64_tr_b16 a[134:135], v35 offset:34816
    ds_read_b64_tr_b16 a[136:137], v36 offset:32768
    ds_read_b64_tr_b16 a[138:139], v36 offset:34816
    ds_read_b64_tr_b16 a[140:141], v37 offset:32768
    ds_read_b64_tr_b16 a[142:143], v37 offset:34816
    ds_read_b64_tr_b16 a[144:145], v42 offset:16384
    ds_read_b64_tr_b16 a[146:147], v42 offset:18432
    ds_read_b64_tr_b16 a[148:149], v43 offset:16384
    ds_read_b64_tr_b16 a[150:151], v43 offset:18432
    ds_read_b64_tr_b16 a[152:153], v44 offset:16384
    ds_read_b64_tr_b16 a[154:155], v44 offset:18432
    ds_read_b64_tr_b16 a[156:157], v45 offset:16384
    ds_read_b64_tr_b16 a[158:159], v45 offset:18432
    ds_read_b64_tr_b16 a[160:161], v34 offset:49152
    ds_read_b64_tr_b16 a[162:163], v34 offset:51200
    ds_read_b64_tr_b16 a[164:165], v35 offset:49152
    ds_read_b64_tr_b16 a[166:167], v35 offset:51200
    ds_read_b64_tr_b16 a[168:169], v36 offset:49152
    ds_read_b64_tr_b16 a[170:171], v36 offset:51200
    ds_read_b64_tr_b16 a[172:173], v37 offset:49152
    ds_read_b64_tr_b16 a[174:175], v37 offset:51200
    s_waitcnt vmcnt(12)
    ds_read_b64_tr_b16 a[176:177], v34 offset:0
    ds_read_b64_tr_b16 a[178:179], v34 offset:2048
    ds_read_b64_tr_b16 a[180:181], v35 offset:0
    ds_read_b64_tr_b16 a[182:183], v35 offset:2048
    ds_read_b64_tr_b16 a[184:185], v36 offset:0
    ds_read_b64_tr_b16 a[186:187], v36 offset:2048
    ds_read_b64_tr_b16 a[188:189], v37 offset:0
    ds_read_b64_tr_b16 a[190:191], v37 offset:2048
    s_waitcnt lgkmcnt(0)
    s_cmp_ge_u32 s4, 14
    s_cbranch_scc1 Lgh_ok
    s_mov_b32 s62, 0
Lgh_spin:
    s_mov_b32 s4, 0
    s_atomic_add s4, s[78:79], s63 glc
    s_add_u32 s62, s62, 1
    s_waitcnt lgkmcnt(0)
    s_cmp_ge_u32 s4, 14
    s_cbranch_scc1 Lgh_ok
    s_cmp_lt_u32 s62, 0x40000
    s_cbranch_scc1 Lgh_spin
Lgh_ok:
    buffer_load_dwordx4 v[128:131], v30, s[32:35], s8 offen offset:0 sc1
    buffer_load_dwordx4 v[132:135], v30, s[32:35], s8 offen offset:1024 sc1
    buffer_load_dwordx4 v[136:139], v30, s[32:35], s9 offen offset:0 sc1
    s_waitcnt vmcnt(7)
    ds_read_b64_tr_b16 a[192:193], v38 offset:0
    ds_read_b64_tr_b16 a[194:195], v38 offset:2048
    ds_read_b64_tr_b16 a[196:197], v39 offset:0
    ds_read_b64_tr_b16 a[198:199], v39 offset:2048
    buffer_load_dwordx4 v[140:143], v30, s[32:35], s9 offen offset:1024 sc1
    ds_read_b64_tr_b16 a[200:201], v40 offset:0
    ds_read_b64_tr_b16 a[202:203], v40 offset:2048
    ds_read_b64_tr_b16 a[204:205], v41 offset:0
    ds_read_b64_tr_b16 a[206:207], v41 offset:2048
    s_waitcnt vmcnt(4)
    ds_read_b64_tr_b16 a[208:209], v38 offset:16384
Lpad_g2:
    s_cbranch_execz Lret_g
    ds_read_b64_tr_b16 a[210:211], v38 offset:18432
    ds_read_b64_tr_b16 a[212:213], v39 offset:16384
    buffer_load_dwordx4 v[144:147], v30, s[32:35], s10 offen offset:0 sc1
    ds_read_b64_tr_b16 a[214:215], v39 offset:18432
    ds_read_b64_tr_b16 a[216:217], v40 offset:16384
    ds_read_b64_tr_b16 a[218:219], v40 offset:18432
    ds_read_b64_tr_b16 a[220:221], v41 offset:16384
    ds_read_b64_tr_b16 a[222:223], v41 offset:18432
    v_permlane16_swap_b32 v48, v50
    v_permlane16_swap_b32 v49, v51
    buffer_load_dwordx4 v[148:151], v30, s[32:35], s10 offen offset:1024 sc1
    v_permlane16_swap_b32 v52, v54
    v_permlane16_swap_b32 v53, v55
    v_lshlrev_b32 v64, 16, v48
    v_and_b32 v65, s3, v48
    v_lshlrev_b32 v66, 16, v49
    v_and_b32 v67, s3, v49
    v_lshlrev_b32 v68, 16, v50
    v_and_b32 v69, s3, v50
    buffer_load_dwordx4 v[152:155], v30, s[32:35], s11 offen offset:0 sc1
    v_lshlrev_b32 v70, 16, v51
    v_and_b32 v71, s3, v51
    v_lshlrev_b32 v72, 16, v52
    v_and_b32 v73, s3, v52
    v_lshlrev_b32 v74, 16, v53
    v_and_b32 v75, s3, v53
    v_lshlrev_b32_e64 v76, 16, v54
    buffer_load_dwordx4 v[156:159], v30, s[32:35], s11 offen offset:1024 sc1
    v_and_b32 v77, s3, v54
    v_lshlrev_b32 v78, 16, v55
    v_and_b32_e64 v79, s3, v55
L_phaseB:
Lpad_s0:
    s_cbranch_execz Ltramp
    s_waitcnt vmcnt(7)
    v_mfma_f32_16x16x32_bf16 v[192:195], a[0:3], v[128:131], 0
    buffer_load_dwordx4 v[160:163], v30, s[32:35], s12 offen offset:0 sc1
    s_waitcnt vmcnt(7)
    v_mfma_f32_16x16x32_bf16 v[192:195], a[16:19], v[132:135], v[192:195]
    v_mfma_f32_16x16x32_bf16 v[196:199], a[20:23], v[132:135], 0
    buffer_load_dwordx4 v[164:167], v30, s[32:35], s12 offen offset:1024 sc1
    v_mfma_f32_16x16x32_bf16 v[196:199], a[4:7], v[128:131], v[196:199]
    v_mfma_f32_16x16x32_bf16 v[200:203], a[8:11], v[128:131], 0
    buffer_load_dwordx4 v[168:171], v30, s[32:35], s13 offen offset:0 sc1
    v_mfma_f32_16x16x32_bf16 v[200:203], a[24:27], v[132:135], v[200:203]
    v_mfma_f32_16x16x32_bf16 v[204:207], a[28:31], v[132:135], 0
    buffer_load_dwordx4 v[172:175], v30, s[32:35], s13 offen offset:1024 sc1
    v_mfma_f32_16x16x32_bf16 v[204:207], a[12:15], v[128:131], v[204:207]
    s_waitcnt vmcnt(9)
    v_mfma_f32_16x16x32_bf16 v[192:195], a[32:35], v[136:139], v[192:195]
    buffer_load_dwordx4 v[176:179], v30, s[32:35], s14 offen offset:0 sc1
    s_waitcnt vmcnt(9)
    v_mfma_f32_16x16x32_bf16 v[192:195], a[48:51], v[140:143], v[192:195]
    s_barrier
    v_mfma_f32_16x16x32_bf16 v[196:199], a[52:55], v[140:143], v[196:199]
    ds_read_b128 v[80:83], v14 offset:32768
    v_mfma_f32_16x16x32_bf16 v[196:199], a[36:39], v[136:139], v[196:199]
    ds_read_b128 v[84:87], v19 offset:32768
    v_mfma_f32_16x16x32_bf16 v[200:203], a[40:43], v[136:139], v[200:203]
    buffer_load_dwordx4 v[180:183], v30, s[32:35], s14 offen offset:1024 sc1
    v_mfma_f32_16x16x32_bf16 v[200:203], a[56:59], v[140:143], v[200:203]
    ds_read_b128 v[88:91], v14 offset:36864
    v_mfma_f32_16x16x32_bf16 v[204:207], a[60:63], v[140:143], v[204:207]
    ds_read_b128 v[92:95], v19 offset:36864
    v_mfma_f32_16x16x32_bf16 v[204:207], a[44:47], v[136:139], v[204:207]
    ds_read_b128 v[96:99], v14 offset:40960
    s_waitcnt vmcnt(9)
    v_mfma_f32_16x16x32_bf16 v[192:195], a[64:67], v[144:147], v[192:195]
    buffer_load_dwordx4 v[184:187], v31, s[32:35], s8 offen offset:0 sc1
    s_waitcnt vmcnt(9)
    v_mfma_f32_16x16x32_bf16 v[192:195], a[80:83], v[148:151], v[192:195]
    s_mov_b32 s4, 0
    s_atomic_add s4, s[78:79], s61 glc
    v_mfma_f32_16x16x32_bf16 v[196:199], a[84:87], v[148:151], v[196:199]
    ds_read_b128 v[100:103], v19 offset:40960
    v_mfma_f32_16x16x32_bf16 v[196:199], a[68:71], v[144:147], v[196:199]
    ds_read_b128 v[104:107], v14 offset:45056
    s_waitcnt lgkmcnt(6)
    v_mfma_f32_16x16x32_bf16 v[208:211], v[80:83], a[240:243], v[64:67]
    buffer_load_dwordx4 v[188:191], v31, s[32:35], s8 offen offset:1024 sc1
    v_mfma_f32_16x16x32_bf16 v[240:243], v[80:83], a[224:227], v[72:75]
    ds_read_b128 v[108:111], v19 offset:45056
    s_waitcnt lgkmcnt(6)
    v_mfma_f32_16x16x32_bf16 v[244:247], v[84:87], a[224:227], v[76:79]
    ds_read_b32 v7, v14
    v_mfma_f32_16x16x32_bf16 v[212:215], v[84:87], a[240:243], v[68:71]
    v_mfma_f32_16x16x32_bf16 v[200:203], a[72:75], v[144:147], v[200:203]
    buffer_load_dwordx4 v[128:131], v31, s[32:35], s9 offen offset:0 sc1
    v_mfma_f32_16x16x32_bf16 v[200:203], a[88:91], v[148:151], v[200:203]
    v_mfma_f32_16x16x32_bf16 v[204:207], a[92:95], v[148:151], v[204:207]
    v_mfma_f32_16x16x32_bf16 v[204:207], a[76:79], v[144:147], v[204:207]
    s_waitcnt lgkmcnt(6)
    v_mfma_f32_16x16x32_bf16 v[208:211], v[88:91], a[244:247], v[208:211]
    buffer_load_dwordx4 v[132:135], v31, s[32:35], s9 offen offset:1024 sc1
    v_mfma_f32_16x16x32_bf16 v[240:243], v[88:91], a[228:231], v[240:243]
    s_waitcnt lgkmcnt(5)
    v_mfma_f32_16x16x32_bf16 v[244:247], v[92:95], a[228:231], v[244:247]
    v_mfma_f32_16x16x32_bf16 v[212:215], v[92:95], a[244:247], v[212:215]
    s_waitcnt vmcnt(11)
    v_mfma_f32_16x16x32_bf16 v[192:195], a[96:99], v[152:155], v[192:195]
    buffer_load_dwordx4 v[136:139], v31, s[32:35], s10 offen offset:0 sc1
    s_waitcnt vmcnt(11)
    v_mfma_f32_16x16x32_bf16 v[192:195], a[112:115], v[156:159], v[192:195]
    v_mfma_f32_16x16x32_bf16 v[196:199], a[116:119], v[156:159], v[196:199]
    v_mfma_f32_16x16x32_bf16 v[196:199], a[100:103], v[152:155], v[196:199]
    s_waitcnt lgkmcnt(4)
    v_mfma_f32_16x16x32_bf16 v[208:211], v[96:99], a[248:251], v[208:211]
    buffer_load_dwordx4 v[140:143], v31, s[32:35], s10 offen offset:1024 sc1
    v_mfma_f32_16x16x32_bf16 v[240:243], v[96:99], a[232:235], v[240:243]
    s_waitcnt lgkmcnt(3)
    v_mfma_f32_16x16x32_bf16 v[244:247], v[100:103], a[232:235], v[244:247]
    v_mfma_f32_16x16x32_bf16 v[212:215], v[100:103], a[248:251], v[212:215]
    v_mfma_f32_16x16x32_bf16 v[200:203], a[104:107], v[152:155], v[200:203]
    buffer_load_dwordx4 v[144:147], v31, s[32:35], s11 offen offset:0 sc1
    v_mfma_f32_16x16x32_bf16 v[200:203], a[120:123], v[156:159], v[200:203]
    v_mfma_f32_16x16x32_bf16 v[204:207], a[124:127], v[156:159], v[204:207]
    v_mfma_f32_16x16x32_bf16 v[204:207], a[108:111], v[152:155], v[204:207]
    s_waitcnt lgkmcnt(2)
    v_mfma_f32_16x16x32_bf16 v[208:211], v[104:107], a[252:255], v[208:211]
    buffer_load_dwordx4 v[148:151], v31, s[32:35], s11 offen offset:1024 sc1
    v_mfma_f32_16x16x32_bf16 v[240:243], v[104:107], a[236:239], v[240:243]
    s_waitcnt lgkmcnt(1)
    v_mfma_f32_16x16x32_bf16 v[244:247], v[108:111], a[236:239], v[244:247]
    v_mfma_f32_16x16x32_bf16 v[212:215], v[108:111], a[252:255], v[212:215]
    s_waitcnt vmcnt(13)
    v_mfma_f32_16x16x32_bf16 v[192:195], a[128:131], v[160:163], v[192:195]
    buffer_load_dwordx4 v[152:155], v31, s[32:35], s12 offen offset:0 sc1
    s_waitcnt vmcnt(13)
    v_mfma_f32_16x16x32_bf16 v[192:195], a[144:147], v[164:167], v[192:195]
    v_mfma_f32_16x16x32_bf16 v[196:199], a[148:151], v[164:167], v[196:199]
    v_mfma_f32_16x16x32_bf16 v[196:199], a[132:135], v[160:163], v[196:199]
    v_mfma_f32_16x16x32_bf16 v[200:203], a[136:139], v[160:163], v[200:203]
    buffer_load_dwordx4 v[156:159], v31, s[32:35], s12 offen offset:1024 sc1
    v_mfma_f32_16x16x32_bf16 v[200:203], a[152:155], v[164:167], v[200:203]
    v_mfma_f32_16x16x32_bf16 v[204:207], a[156:159], v[164:167], v[204:207]
    v_mfma_f32_16x16x32_bf16 v[204:207], a[140:143], v[160:163], v[204:207]
    s_waitcnt vmcnt(13)
    v_mfma_f32_16x16x32_bf16 v[192:195], a[160:163], v[168:171], v[192:195]
    buffer_load_dwordx4 v[160:163], v31, s[32:35], s13 offen offset:0 sc1
    s_waitcnt vmcnt(13)
    v_mfma_f32_16x16x32_bf16 v[192:195], a[176:179], v[172:175], v[192:195]
    v_mfma_f32_16x16x32_bf16 v[196:199], a[180:183], v[172:175], v[196:199]
    v_mfma_f32_16x16x32_bf16 v[196:199], a[164:167], v[168:171], v[196:199]
    v_mfma_f32_16x16x32_bf16 v[200:203], a[168:171], v[168:171], v[200:203]
    buffer_load_dwordx4 v[164:167], v31, s[32:35], s13 offen offset:1024 sc1
    v_mfma_f32_16x16x32_bf16 v[200:203], a[184:187], v[172:175], v[200:203]
    v_mfma_f32_16x16x32_bf16 v[204:207], a[188:191], v[172:175], v[204:207]
    v_mfma_f32_16x16x32_bf16 v[204:207], a[172:175], v[168:171], v[204:207]
    s_waitcnt vmcnt(13)
    v_mfma_f32_16x16x32_bf16 v[192:195], a[192:195], v[176:179], v[192:195]
    s_waitcnt vmcnt(12)
    v_mfma_f32_16x16x32_bf16 v[192:195], a[208:211], v[180:183], v[192:195]
    v_mfma_f32_16x16x32_bf16 v[196:199], a[212:215], v[180:183], v[196:199]
    v_mfma_f32_16x16x32_bf16 v[196:199], a[196:199], v[176:179], v[196:199]
    v_mfma_f32_16x16x32_bf16 v[200:203], a[200:203], v[176:179], v[200:203]
    buffer_load_dwordx4 v[168:171], v31, s[32:35], s14 offen offset:0 sc1
    v_mfma_f32_16x16x32_bf16 v[200:203], a[216:219], v[180:183], v[200:203]
    v_mfma_f32_16x16x32_bf16 v[204:207], a[220:223], v[180:183], v[204:207]
    v_mfma_f32_16x16x32_bf16 v[204:207], a[204:207], v[176:179], v[204:207]
    s_waitcnt vmcnt(12)
    v_mfma_f32_16x16x32_bf16 v[208:211], a[0:3], v[184:187], v[208:211]
    buffer_load_dwordx4 v[172:175], v31, s[32:35], s14 offen offset:1024 sc1
    s_waitcnt vmcnt(12)
    v_mfma_f32_16x16x32_bf16 v[208:211], a[16:19], v[188:191], v[208:211]
    s_waitcnt lgkmcnt(0)
    s_cmp_ge_u32 s4, 14
    s_cbranch_scc0 Ll_slow
Ll_ok:
    v_mfma_f32_16x16x32_bf16 v[212:215], a[20:23], v[188:191], v[212:215]
    v_mfma_f32_16x16x32_bf16 v[212:215], a[4:7], v[184:187], v[212:215]
    v_mfma_f32_16x16x32_bf16 v[216:219], a[8:11], v[184:187], 0
    buffer_load_dwordx4 v[176:179], v32, s[32:35], s8 offen offset:0 sc1
    v_mfma_f32_16x16x32_bf16 v[216:219], a[24:27], v[188:191], v[216:219]
    ds_write_b128 v15, v[192:195] offset:0
    v_mfma_f32_16x16x32_bf16 v[220:223], a[28:31], v[188:191], 0
    v_mfma_f32_16x16x32_bf16 v[220:223], a[12:15], v[184:187], v[220:223]
    s_waitcnt vmcnt(12)
    v_mfma_f32_16x16x32_bf16 v[208:211], a[32:35], v[128:131], v[208:211]
    buffer_load_dwordx4 v[180:183], v32, s[32:35], s8 offen offset:1024 sc1
    s_waitcnt vmcnt(12)
    v_mfma_f32_16x16x32_bf16 v[208:211], a[48:51], v[132:135], v[208:211]
    ds_write_b128 v15, v[196:199] offset:1024
    v_mfma_f32_16x16x32_bf16 v[212:215], a[52:55], v[132:135], v[212:215]
    v_mfma_f32_16x16x32_bf16 v[212:215], a[36:39], v[128:131], v[212:215]
    v_mfma_f32_16x16x32_bf16 v[216:219], a[40:43], v[128:131], v[216:219]
    buffer_load_dwordx4 v[184:187], v32, s[32:35], s9 offen offset:0 sc1
    v_mfma_f32_16x16x32_bf16 v[216:219], a[56:59], v[132:135], v[216:219]
    ds_write_b128 v15, v[200:203] offset:2048
    v_mfma_f32_16x16x32_bf16 v[220:223], a[60:63], v[132:135], v[220:223]
    v_mfma_f32_16x16x32_bf16 v[220:223], a[44:47], v[128:131], v[220:223]
    s_waitcnt vmcnt(12)
    v_mfma_f32_16x16x32_bf16 v[208:211], a[64:67], v[136:139], v[208:211]
    s_waitcnt vmcnt(11)
    v_mfma_f32_16x16x32_bf16 v[208:211], a[80:83], v[140:143], v[208:211]
    ds_write_b128 v15, v[204:207] offset:3072
    v_mfma_f32_16x16x32_bf16 v[212:215], a[84:87], v[140:143], v[212:215]
    v_mfma_f32_16x16x32_bf16 v[212:215], a[68:71], v[136:139], v[212:215]
    v_mfma_f32_16x16x32_bf16 v[216:219], a[72:75], v[136:139], v[216:219]
    buffer_load_dwordx4 v[188:191], v32, s[32:35], s9 offen offset:1024 sc1
    v_mfma_f32_16x16x32_bf16 v[216:219], a[88:91], v[140:143], v[216:219]
    v_mfma_f32_16x16x32_bf16 v[220:223], a[92:95], v[140:143], v[220:223]
    v_mfma_f32_16x16x32_bf16 v[220:223], a[76:79], v[136:139], v[220:223]
    s_waitcnt vmcnt(11)
    v_mfma_f32_16x16x32_bf16 v[208:211], a[96:99], v[144:147], v[208:211]
    buffer_load_dwordx4 v[128:131], v32, s[32:35], s10 offen offset:0 sc1
    s_waitcnt vmcnt(11)
    v_mfma_f32_16x16x32_bf16 v[208:211], a[112:115], v[148:151], v[208:211]
    v_mfma_f32_16x16x32_bf16 v[212:215], a[116:119], v[148:151], v[212:215]
    v_mfma_f32_16x16x32_bf16 v[212:215], a[100:103], v[144:147], v[212:215]
    v_mfma_f32_16x16x32_bf16 v[216:219], a[104:107], v[144:147], v[216:219]
    buffer_load_dwordx4 v[132:135], v32, s[32:35], s10 offen offset:1024 sc1
    v_mfma_f32_16x16x32_bf16 v[216:219], a[120:123], v[148:151], v[216:219]
    v_mfma_f32_16x16x32_bf16 v[220:223], a[124:127], v[148:151], v[220:223]
    v_mfma_f32_16x16x32_bf16 v[220:223], a[108:111], v[144:147], v[220:223]
    s_waitcnt vmcnt(11)
    v_mfma_f32_16x16x32_bf16 v[208:211], a[128:131], v[152:155], v[208:211]
    buffer_load_dwordx4 v[136:139], v32, s[32:35], s11 offen offset:0 sc1
    s_waitcnt vmcnt(11)
    v_mfma_f32_16x16x32_bf16 v[208:211], a[144:147], v[156:159], v[208:211]
    v_mfma_f32_16x16x32_bf16 v[212:215], a[148:151], v[156:159], v[212:215]
    v_mfma_f32_16x16x32_bf16 v[212:215], a[132:135], v[152:155], v[212:215]
    v_mfma_f32_16x16x32_bf16 v[216:219], a[136:139], v[152:155], v[216:219]
    buffer_load_dwordx4 v[140:143], v32, s[32:35], s11 offen offset:1024 sc1
    v_mfma_f32_16x16x32_bf16 v[216:219], a[152:155], v[156:159], v[216:219]
    v_mfma_f32_16x16x32_bf16 v[220:223], a[156:159], v[156:159], v[220:223]
    v_mfma_f32_16x16x32_bf16 v[220:223], a[140:143], v[152:155], v[220:223]
    s_waitcnt vmcnt(11)
    v_mfma_f32_16x16x32_bf16 v[208:211], a[160:163], v[160:163], v[208:211]
    s_waitcnt vmcnt(10)
    v_mfma_f32_16x16x32_bf16 v[208:211], a[176:179], v[164:167], v[208:211]
    v_mfma_f32_16x16x32_bf16 v[212:215], a[180:183], v[164:167], v[212:215]
    v_mfma_f32_16x16x32_bf16 v[212:215], a[164:167], v[160:163], v[212:215]
    v_mfma_f32_16x16x32_bf16 v[216:219], a[168:171], v[160:163], v[216:219]
    buffer_load_dwordx4 v[144:147], v32, s[32:35], s12 offen offset:0 sc1
    v_mfma_f32_16x16x32_bf16 v[216:219], a[184:187], v[164:167], v[216:219]
    v_mfma_f32_16x16x32_bf16 v[220:223], a[188:191], v[164:167], v[220:223]
    v_mfma_f32_16x16x32_bf16 v[220:223], a[172:175], v[160:163], v[220:223]
    s_waitcnt vmcnt(10)
    v_mfma_f32_16x16x32_bf16 v[208:211], a[192:195], v[168:171], v[208:211]
    buffer_load_dwordx4 v[148:151], v32, s[32:35], s12 offen offset:1024 sc1
    s_waitcnt vmcnt(10)
    v_mfma_f32_16x16x32_bf16 v[208:211], a[208:211], v[172:175], v[208:211]
    v_mfma_f32_16x16x32_bf16 v[212:215], a[212:215], v[172:175], v[212:215]
    v_mfma_f32_16x16x32_bf16 v[212:215], a[196:199], v[168:171], v[212:215]
    v_mfma_f32_16x16x32_bf16 v[216:219], a[200:203], v[168:171], v[216:219]
    buffer_load_dwordx4 v[152:155], v32, s[32:35], s13 offen offset:0 sc1
    v_mfma_f32_16x16x32_bf16 v[216:219], a[216:219], v[172:175], v[216:219]
    v_mfma_f32_16x16x32_bf16 v[220:223], a[220:223], v[172:175], v[220:223]
    v_mfma_f32_16x16x32_bf16 v[220:223], a[204:207], v[168:171], v[220:223]
    s_waitcnt vmcnt(10)
    v_mfma_f32_16x16x32_bf16 v[224:227], a[0:3], v[176:179], 0
    buffer_load_dwordx4 v[156:159], v32, s[32:35], s13 offen offset:1024 sc1
    s_waitcnt vmcnt(10)
    v_mfma_f32_16x16x32_bf16 v[224:227], a[16:19], v[180:183], v[224:227]
    v_mfma_f32_16x16x32_bf16 v[228:231], a[20:23], v[180:183], 0
    v_mfma_f32_16x16x32_bf16 v[228:231], a[4:7], v[176:179], v[228:231]
    v_mfma_f32_16x16x32_bf16 v[232:235], a[8:11], v[176:179], 0
    buffer_load_dwordx4 v[160:163], v32, s[32:35], s14 offen offset:0 sc1
    v_mfma_f32_16x16x32_bf16 v[232:235], a[24:27], v[180:183], v[232:235]
    ds_write_b128 v15, v[216:219] offset:49152
    v_mfma_f32_16x16x32_bf16 v[236:239], a[28:31], v[180:183], 0
    v_mfma_f32_16x16x32_bf16 v[236:239], a[12:15], v[176:179], v[236:239]
    s_waitcnt vmcnt(10)
    v_mfma_f32_16x16x32_bf16 v[224:227], a[32:35], v[184:187], v[224:227]
    s_waitcnt vmcnt(9)
    v_mfma_f32_16x16x32_bf16 v[224:227], a[48:51], v[188:191], v[224:227]
    ds_write_b128 v15, v[220:223] offset:50176
    v_mfma_f32_16x16x32_bf16 v[228:231], a[52:55], v[188:191], v[228:231]
    v_mfma_f32_16x16x32_bf16 v[228:231], a[36:39], v[184:187], v[228:231]
    v_mfma_f32_16x16x32_bf16 v[232:235], a[40:43], v[184:187], v[232:235]
    buffer_load_dwordx4 v[164:167], v32, s[32:35], s14 offen offset:1024 sc1
    v_mfma_f32_16x16x32_bf16 v[232:235], a[56:59], v[188:191], v[232:235]
    v_mfma_f32_16x16x32_bf16 v[236:239], a[60:63], v[188:191], v[236:239]
    v_mfma_f32_16x16x32_bf16 v[236:239], a[44:47], v[184:187], v[236:239]
    s_waitcnt vmcnt(9)
    v_mfma_f32_16x16x32_bf16 v[224:227], a[64:67], v[128:131], v[224:227]
    buffer_load_dwordx4 v[168:171], v33, s[32:35], s8 offen offset:0 sc1
    s_waitcnt vmcnt(9)
    v_mfma_f32_16x16x32_bf16 v[224:227], a[80:83], v[132:135], v[224:227]
    v_mfma_f32_16x16x32_bf16 v[228:231], a[84:87], v[132:135], v[228:231]
    v_mfma_f32_16x16x32_bf16 v[228:231], a[68:71], v[128:131], v[228:231]
    v_mfma_f32_16x16x32_bf16 v[232:235], a[72:75], v[128:131], v[232:235]
    buffer_load_dwordx4 v[172:175], v33, s[32:35], s8 offen offset:1024 sc1
    v_mfma_f32_16x16x32_bf16 v[232:235], a[88:91], v[132:135], v[232:235]
    v_mfma_f32_16x16x32_bf16 v[236:239], a[92:95], v[132:135], v[236:239]
    v_mfma_f32_16x16x32_bf16 v[236:239], a[76:79], v[128:131], v[236:239]
    s_waitcnt vmcnt(9)
    v_mfma_f32_16x16x32_bf16 v[224:227], a[96:99], v[136:139], v[224:227]
    buffer_load_dwordx4 v[176:179], v33, s[32:35], s9 offen offset:0 sc1
    s_waitcnt vmcnt(9)
    v_mfma_f32_16x16x32_bf16 v[224:227], a[112:115], v[140:143], v[224:227]
    s_waitcnt lgkmcnt(0)
    s_barrier
    v_mfma_f32_16x16x32_bf16 v[228:231], a[116:119], v[140:143], v[228:231]
    ds_read_b128 v[112:115], v20 offset:0
    v_mfma_f32_16x16x32_bf16 v[228:231], a[100:103], v[136:139], v[228:231]
    ds_read_b128 v[116:119], v20 offset:1024
    v_mfma_f32_16x16x32_bf16 v[232:235], a[104:107], v[136:139], v[232:235]
    buffer_load_dwordx4 v[180:183], v33, s[32:35], s9 offen offset:1024 sc1
    v_mfma_f32_16x16x32_bf16 v[232:235], a[120:123], v[140:143], v[232:235]
    ds_read_b128 v[120:123], v21 offset:2048
    v_mfma_f32_16x16x32_bf16 v[236:239], a[124:127], v[140:143], v[236:239]
    ds_read_b128 v[124:127], v21 offset:3072
    v_mfma_f32_16x16x32_bf16 v[236:239], a[108:111], v[136:139], v[236:239]
    ds_read_b128 v[48:51], v18 offset:49152
    s_waitcnt vmcnt(9)
    v_mfma_f32_16x16x32_bf16 v[224:227], a[128:131], v[144:147], v[224:227]
    buffer_load_dwordx4 v[184:187], v33, s[32:35], s10 offen offset:0 sc1
    s_waitcnt vmcnt(9)
    v_mfma_f32_16x16x32_bf16 v[224:227], a[144:147], v[148:151], v[224:227]
    ds_read_b128 v[52:55], v18 offset:50176
    v_mfma_f32_16x16x32_bf16 v[228:231], a[148:151], v[148:151], v[228:231]
    s_waitcnt lgkmcnt(3)
    v_add_f32 v112, v112, v120
    v_add_f32_e64 v113, v113, v121
    v_mfma_f32_16x16x32_bf16 v[228:231], a[132:135], v[144:147], v[228:231]
    v_add_f32_e64 v114, v114, v122
    v_mfma_f32_16x16x32_bf16 v[232:235], a[136:139], v[144:147], v[232:235]
    buffer_load_dwordx4 v[188:191], v33, s[32:35], s10 offen offset:1024 sc1
    v_mfma_f32_16x16x32_bf16 v[232:235], a[152:155], v[148:151], v[232:235]
    v_add_f32 v115, v115, v123
    s_waitcnt lgkmcnt(2)
    v_add_f32_e64 v116, v116, v124
    v_mfma_f32_16x16x32_bf16 v[236:239], a[156:159], v[148:151], v[236:239]
    v_add_f32 v117, v117, v125
    v_add_f32 v118, v118, v126
    v_mfma_f32_16x16x32_bf16 v[236:239], a[140:143], v[144:147], v[236:239]
    v_add_f32 v119, v119, v127
    s_waitcnt vmcnt(9)
    v_mfma_f32_16x16x32_bf16 v[224:227], a[160:163], v[152:155], v[224:227]
    buffer_load_dwordx4 v[128:131], v33, s[32:35], s11 offen offset:0 sc1
    s_waitcnt vmcnt(9)
    v_mfma_f32_16x16x32_bf16 v[224:227], a[176:179], v[156:159], v[224:227]
    s_waitcnt lgkmcnt(1)
    v_add_f32 v112, v112, v48
    v_add_f32 v113, v113, v49
    v_mfma_f32_16x16x32_bf16 v[228:231], a[180:183], v[156:159], v[228:231]
    v_add_f32 v114, v114, v50
    v_add_f32 v115, v115, v51
    v_mfma_f32_16x16x32_bf16 v[228:231], a[164:167], v[152:155], v[228:231]
    s_waitcnt lgkmcnt(0)
    v_add_f32 v116, v116, v52
    v_mfma_f32_16x16x32_bf16 v[232:235], a[168:171], v[152:155], v[232:235]
    buffer_load_dwordx4 v[132:135], v33, s[32:35], s11 offen offset:1024 sc1
    v_mfma_f32_16x16x32_bf16 v[232:235], a[184:187], v[156:159], v[232:235]
    v_add_f32 v117, v117, v53
    v_add_f32 v118, v118, v54
    v_mfma_f32_16x16x32_bf16 v[236:239], a[188:191], v[156:159], v[236:239]
    v_add_f32 v119, v119, v55
    v_add_f32 v112, v112, v208
    v_mfma_f32_16x16x32_bf16 v[236:239], a[172:175], v[152:155], v[236:239]
    v_add_f32 v113, v113, v209
    s_waitcnt vmcnt(9)
    v_mfma_f32_16x16x32_bf16 v[224:227], a[192:195], v[160:163], v[224:227]
    buffer_load_dwordx4 v[136:139], v33, s[32:35], s12 offen offset:0 sc1
    s_waitcnt vmcnt(9)
    v_mfma_f32_16x16x32_bf16 v[224:227], a[208:211], v[164:167], v[224:227]
    v_add_f32 v114, v114, v210
    v_add_f32_e64 v115, v115, v211
    v_mfma_f32_16x16x32_bf16 v[228:231], a[212:215], v[164:167], v[228:231]
    v_add_f32 v116, v116, v212
    v_add_f32 v117, v117, v213
    v_mfma_f32_16x16x32_bf16 v[228:231], a[196:199], v[160:163], v[228:231]
    v_add_f32_e64 v118, v118, v214
    v_mfma_f32_16x16x32_bf16 v[232:235], a[200:203], v[160:163], v[232:235]
    buffer_load_dwordx4 v[140:143], v33, s[32:35], s12 offen offset:1024 sc1
    v_mfma_f32_16x16x32_bf16 v[232:235], a[216:219], v[164:167], v[232:235]
    v_add_f32_e64 v119, v119, v215
    v_cvt_pk_bf16_f32 v56, v112, v113
    v_mfma_f32_16x16x32_bf16 v[236:239], a[220:223], v[164:167], v[236:239]
    v_cvt_pk_bf16_f32 v57, v114, v115
    v_cvt_pk_bf16_f32 v58, v116, v117
    v_mfma_f32_16x16x32_bf16 v[236:239], a[204:207], v[160:163], v[236:239]
    v_cvt_pk_bf16_f32 v59, v118, v119
    s_waitcnt vmcnt(9)
    v_mfma_f32_16x16x32_bf16 v[240:243], a[0:3], v[168:171], v[240:243]
    buffer_load_dwordx4 v[144:147], v33, s[32:35], s13 offen offset:0 sc1
    s_waitcnt vmcnt(9)
    v_mfma_f32_16x16x32_bf16 v[240:243], a[16:19], v[172:175], v[240:243]
    v_permlane16_swap_b32 v56, v58
    v_permlane16_swap_b32 v57, v59
    v_mfma_f32_16x16x32_bf16 v[244:247], a[20:23], v[172:175], v[244:247]
    v_mfma_f32_16x16x32_bf16 v[244:247], a[4:7], v[168:171], v[244:247]
    v_mfma_f32_16x16x32_bf16 v[248:251], a[8:11], v[168:171], 0
    buffer_load_dwordx4 v[148:151], v33, s[32:35], s13 offen offset:1024 sc1
    v_mfma_f32_16x16x32_bf16 v[248:251], a[24:27], v[172:175], v[248:251]
    ds_write_b128 v15, v[224:227] offset:16384
    v_mfma_f32_16x16x32_bf16 v[252:255], a[28:31], v[172:175], 0
    v_mfma_f32_16x16x32_bf16 v[252:255], a[12:15], v[168:171], v[252:255]
    s_waitcnt vmcnt(9)
    v_mfma_f32_16x16x32_bf16 v[240:243], a[32:35], v[176:179], v[240:243]
    buffer_load_dwordx4 v[152:155], v33, s[32:35], s14 offen offset:0 sc1
    s_waitcnt vmcnt(9)
    v_mfma_f32_16x16x32_bf16 v[240:243], a[48:51], v[180:183], v[240:243]
    ds_write_b128 v15, v[228:231] offset:17408
    v_mfma_f32_16x16x32_bf16 v[244:247], a[52:55], v[180:183], v[244:247]
    v_mfma_f32_16x16x32_bf16 v[244:247], a[36:39], v[176:179], v[244:247]
    v_mfma_f32_16x16x32_bf16 v[248:251], a[40:43], v[176:179], v[248:251]
    buffer_load_dwordx4 v[156:159], v33, s[32:35], s14 offen offset:1024 sc1
    v_mfma_f32_16x16x32_bf16 v[248:251], a[56:59], v[180:183], v[248:251]
    ds_write_b128 v15, v[232:235] offset:18432
    v_mfma_f32_16x16x32_bf16 v[252:255], a[60:63], v[180:183], v[252:255]
    v_mfma_f32_16x16x32_bf16 v[252:255], a[44:47], v[176:179], v[252:255]
    s_waitcnt vmcnt(9)
    v_mfma_f32_16x16x32_bf16 v[240:243], a[64:67], v[184:187], v[240:243]
    s_waitcnt vmcnt(8)
    v_mfma_f32_16x16x32_bf16 v[240:243], a[80:83], v[188:191], v[240:243]
    ds_write_b128 v15, v[236:239] offset:19456
    v_mfma_f32_16x16x32_bf16 v[244:247], a[84:87], v[188:191], v[244:247]
    v_mfma_f32_16x16x32_bf16 v[244:247], a[68:71], v[184:187], v[244:247]
    v_mfma_f32_16x16x32_bf16 v[248:251], a[72:75], v[184:187], v[248:251]
    v_mfma_f32_16x16x32_bf16 v[248:251], a[88:91], v[188:191], v[248:251]
    v_mfma_f32_16x16x32_bf16 v[252:255], a[92:95], v[188:191], v[252:255]
    v_mfma_f32_16x16x32_bf16 v[252:255], a[76:79], v[184:187], v[252:255]
    s_waitcnt vmcnt(7)
    v_mfma_f32_16x16x32_bf16 v[240:243], a[96:99], v[128:131], v[240:243]
    s_waitcnt vmcnt(6)
    v_mfma_f32_16x16x32_bf16 v[240:243], a[112:115], v[132:135], v[240:243]
    s_waitcnt lgkmcnt(0)
    s_barrier
    v_mfma_f32_16x16x32_bf16 v[244:247], a[116:119], v[132:135], v[244:247]
    ds_read_b128 v[160:163], v20 offset:16384
    v_mfma_f32_16x16x32_bf16 v[244:247], a[100:103], v[128:131], v[244:247]
    ds_read_b128 v[164:167], v20 offset:17408
    v_mfma_f32_16x16x32_bf16 v[248:251], a[104:107], v[128:131], v[248:251]
    ds_read_b128 v[168:171], v21 offset:18432
    v_mfma_f32_16x16x32_bf16 v[248:251], a[120:123], v[132:135], v[248:251]
    ds_read_b128 v[172:175], v21 offset:19456
    v_mfma_f32_16x16x32_bf16 v[252:255], a[124:127], v[132:135], v[252:255]
    v_mfma_f32_16x16x32_bf16 v[252:255], a[108:111], v[128:131], v[252:255]
    s_waitcnt vmcnt(5)
    v_mfma_f32_16x16x32_bf16 v[240:243], a[128:131], v[136:139], v[240:243]
    s_waitcnt vmcnt(4)
    v_mfma_f32_16x16x32_bf16 v[240:243], a[144:147], v[140:143], v[240:243]
    v_mfma_f32_16x16x32_bf16 v[244:247], a[148:151], v[140:143], v[244:247]
    v_mfma_f32_16x16x32_bf16 v[244:247], a[132:135], v[136:139], v[244:247]
    v_mfma_f32_16x16x32_bf16 v[248:251], a[136:139], v[136:139], v[248:251]
    buffer_store_dwordx4 v[56:59], v13, s[40:43], 0 offen sc1
    s_waitcnt lgkmcnt(1)
    v_add_f32 v160, v160, v168
    v_mfma_f32_16x16x32_bf16 v[248:251], a[152:155], v[140:143], v[248:251]
    v_add_f32 v161, v161, v169
    v_add_f32 v162, v162, v170
    v_mfma_f32_16x16x32_bf16 v[252:255], a[156:159], v[140:143], v[252:255]
    v_add_f32 v163, v163, v171
    s_waitcnt lgkmcnt(0)
    v_add_f32_e64 v164, v164, v172
    v_mfma_f32_16x16x32_bf16 v[252:255], a[140:143], v[136:139], v[252:255]
    v_add_f32 v165, v165, v173
    s_waitcnt vmcnt(4)
    v_mfma_f32_16x16x32_bf16 v[248:251], a[168:171], v[144:147], v[248:251]
    v_add_f32_e64 v166, v166, v174
    v_add_f32 v167, v167, v175
    s_waitcnt vmcnt(3)
    v_mfma_f32_16x16x32_bf16 v[248:251], a[184:187], v[148:151], v[248:251]
    v_mfma_f32_16x16x32_bf16 v[252:255], a[188:191], v[148:151], v[252:255]
    v_mfma_f32_16x16x32_bf16 v[252:255], a[172:175], v[144:147], v[252:255]
    s_waitcnt vmcnt(2)
    v_mfma_f32_16x16x32_bf16 v[248:251], a[200:203], v[152:155], v[248:251]
    s_waitcnt vmcnt(1)
    v_mfma_f32_16x16x32_bf16 v[248:251], a[216:219], v[156:159], v[248:251]
    v_mfma_f32_16x16x32_bf16 v[252:255], a[220:223], v[156:159], v[252:255]
    v_mfma_f32_16x16x32_bf16 v[252:255], a[204:207], v[152:155], v[252:255]
    v_mfma_f32_16x16x32_bf16 v[240:243], a[160:163], v[144:147], v[240:243]
    v_mfma_f32_16x16x32_bf16 v[240:243], a[176:179], v[148:151], v[240:243]
    v_mfma_f32_16x16x32_bf16 v[240:243], a[192:195], v[152:155], v[240:243]
    s_nop 2
    ds_write_b128 v15, v[248:251] offset:51200
    v_mfma_f32_16x16x32_bf16 v[240:243], a[208:211], v[156:159], v[240:243]
    ds_write_b128 v15, v[252:255] offset:52224
    v_mfma_f32_16x16x32_bf16 v[244:247], a[164:167], v[144:147], v[244:247]
    v_mfma_f32_16x16x32_bf16 v[244:247], a[180:183], v[148:151], v[244:247]
    v_mfma_f32_16x16x32_bf16 v[244:247], a[196:199], v[152:155], v[244:247]
    v_mfma_f32_16x16x32_bf16 v[244:247], a[212:215], v[156:159], v[244:247]
    s_waitcnt lgkmcnt(0)
    s_barrier
    ds_read_b128 v[176:179], v18 offset:51200
    ds_read_b128 v[180:183], v18 offset:52224
    v_pk_add_f32 v[160:161], v[160:161], v[240:241]
    v_pk_add_f32 v[162:163], v[162:163], v[242:243]
    s_nop 1
    v_pk_add_f32 v[164:165], v[164:165], v[244:245]
    v_pk_add_f32 v[166:167], v[166:167], v[246:247]
    s_waitcnt lgkmcnt(1)
    v_pk_add_f32 v[160:161], v[160:161], v[176:177]
    v_pk_add_f32 v[162:163], v[162:163], v[178:179]
    s_waitcnt lgkmcnt(0)
    v_pk_add_f32 v[164:165], v[164:165], v[180:181]
    v_pk_add_f32 v[166:167], v[166:167], v[182:183]
    v_cvt_pk_bf16_f32 v60, v160, v161
    v_cvt_pk_bf16_f32 v61, v162, v163
    v_cvt_pk_bf16_f32 v62, v164, v165
    v_cvt_pk_bf16_f32 v63, v166, v167
    s_nop 0
    v_permlane16_swap_b32 v60, v62
    v_permlane16_swap_b32 v61, v63
    buffer_store_dwordx4 v[60:63], v13, s[40:43], s86 offen sc1
L_end:
    s_endpgm
.p2align 3
L_dft:
    s_lshl_b32 s48, s44, 16
    v_lshrrev_b32 v241, 3, v1
    v_lshl_add_u32 v241, v241, 13, s48
    v_lshlrev_b32 v240, 1, v3
    v_xor_b32 v240, v240, v1
    v_and_b32_e64 v240, 7, v240
    v_lshl_add_u32 v240, v240, 4, v241
    v_xor_b32_e64 v241, 16, v240
    v_add_u32 v241, 1024, v241
    s_lshr_b32 s57, s64, 1
    v_lshrrev_b32 v243, 1, v2
    v_and_b32_e64 v244, 1, v2
    v_and_or_b32 v242, v243, 6, v244
    v_xor_b32_e64 v242, v242, v3
    v_lshl_add_u32 v243, v244, 3, v243
    v_lshl_add_u32 v242, v243, 3, v242
    v_cmp_eq_u32 vcc, 1, v2
    v_lshlrev_b32 v242, 4, v242
    v_add_u32 v242, 147456, v242
    v_mov_b32 v246, 155648
    v_xor_b32_e64 v243, 64, v242
    v_cndmask_b32 v244, v242, v246, vcc
    v_cndmask_b32 v245, v243, v246, vcc
    v_mov_b32 v248, 0xbf803f80
    v_mov_b32 v249, 0xbf803f80
    v_mov_b32 v250, 0xbf803f80
    v_mov_b32 v251, 0xbf803f80
    s_add_u32 m0, s57, 147456
    s_nop 0
    buffer_load_dwordx4 v240, s[24:27], 0 offen lds
    buffer_load_dwordx4 v241, s[28:31], 0 offen offset:1024 lds
    ds_write_b128 v246, v[248:251]
    s_lshl_b32 s50, s80, 10
    s_lshl_b32 s49, s44, 1
    s_and_b32 s49, s49, 2
    s_xor_b32 s49, s49, s44
    s_cmp_eq_u32 s45, 0
    s_cselect_b32 s48, s44, s49
    s_cmp_ge_u32 s46, 14
    s_cselect_b32 s48, s48, s44
    s_lshl_b32 s71, s45, 2
    s_add_u32 s71, s71, s48
    s_lshl_b32 s71, s71, 12
    s_and_b32 s49, s50, 2048
    s_add_u32 s71, s71, s49
    s_add_u32 s71, s71, 10551296
    s_lshl_b32 s81, s46, 14
    s_add_u32 s81, s81, s64
    s_add_u32 s81, s81, 10813440
    s_add_u32 s48, s46, 16
    s_bitcmp1_b32 s44, 0
    s_cselect_b32 s48, s48, s45
    s_cselect_b32 s49, 0, 2
    s_cselect_b32 s53, 16, 8
    s_and_b32 s49, s49, s80
    s_lshr_b32 s50, s44, 1
    s_add_u32 s49, s49, s50
    s_lshl_b32 s48, s48, 2
    s_add_u32 s48, s48, s49
    s_lshl_b32 s48, s48, 7
    s_add_u32 s56, s48, 10502144
    s_and_b32 s8, s6, 7
    s_mul_i32 s8, s8, 7
    s_add_u32 s8, s8, 2
    s_lshr_b32 s8, s8, 3
    s_lshl_b32 s8, s8, 11
    s_add_u32 s9, s8, 2048
    s_cmp_eq_u32 s9, 14336
    s_cselect_b32 s9, 0, s9
    s_add_u32 s10, s9, 2048
    s_cmp_eq_u32 s10, 14336
    s_cselect_b32 s10, 0, s10
    s_add_u32 s11, s10, 2048
    s_cmp_eq_u32 s11, 14336
    s_cselect_b32 s11, 0, s11
    s_add_u32 s12, s11, 2048
    s_cmp_eq_u32 s12, 14336
    s_cselect_b32 s12, 0, s12
    s_add_u32 s13, s12, 2048
    s_cmp_eq_u32 s13, 14336
    s_cselect_b32 s13, 0, s13
    s_add_u32 s14, s13, 2048
    s_cmp_eq_u32 s14, 14336
    s_cselect_b32 s14, 0, s14
    v_and_b32 v35, 3, v1
    v_bfe_u32 v34, v1, 3, 2
    v_lshl_add_u32 v34, v34, 2, v35
    v_lshrrev_b32_e64 v35, 2, v1
    v_lshl_add_u32 v34, v35, 4, v34
    v_lshl_add_u32 v34, v34, 3, s64
    s_and_b32 s48, s44, 1
    s_lshl_b32 s48, s48, 6
    v_xor_b32 v34, s48, v34
    v_xor_b32 v35, 32, v34
    v_xor_b32_e64 v36, 64, v34
    v_xor_b32 v37, 96, v34
    v_add_u32 v38, 65536, v34
    v_add_u32 v39, 65536, v35
    v_add_u32 v40, 65536, v36
    v_add_u32 v41, 65536, v37
    v_add_u32 v42, 131072, v34
    v_add_u32 v43, 131072, v35
    v_add_u32 v44, 131072, v36
    v_add_u32 v45, 131072, v37
    s_mul_i32 s48, s44, 458752
    s_lshl_b32 s49, s7, 7
    s_add_u32 s48, s48, s49
    v_lshrrev_b32_e64 v23, 3, v1
    v_lshl_add_u32 v23, v23, 10, s48
    v_and_b32 v22, 7, v1
    v_lshlrev_b32 v24, 1, v3
    v_xor_b32_e64 v22, v22, v24
    v_lshl_add_u32 v22, v22, 4, v23
    v_add_u32 v23, 7168, v22
    v_add_u32 v24, 14336, v22
    v_add_u32 v25, 21504, v22
    s_mov_b32 s3, 0xffff0000
    v_add_u32 v30, 65536, v28
    v_add_u32 v31, 65536, v29
    v_lshl_add_u32 v32, v1, 4, s64
    s_bitcmp1_b32 s46, 0
    s_cselect_b32 s16, -1.0, 1.0
    s_or_b32 s16, s16, 0x3f80
    s_mov_b32 s18, 0x05040100
    s_mov_b32 s19, 0x07060302
    s_waitcnt lgkmcnt(0)
    s_waitcnt vmcnt(15)
    ds_read_b128 a[128:131], v28 offset:0
    ds_read_b128 a[132:135], v28 offset:2048
    ds_read_b128 a[136:139], v29 offset:0
    ds_read_b128 a[140:143], v29 offset:2048
    s_add_u32 m0, s64, 32768
    s_lshl_b32 s65, s68, 7
    buffer_load_dwordx4 v16, s[20:23], s65 offen offset:0 lds
    buffer_load_dwordx4 v17, s[20:23], s65 offen offset:1024 lds
    buffer_load_dwordx4 v18, s[20:23], s65 offen offset:2048 lds
    buffer_load_dwordx4 v19, s[20:23], s65 offen offset:3072 lds
    s_waitcnt lgkmcnt(3)
    v_mfma_f32_16x16x32_bf16 v[96:99], a[168:171], a[128:131], 0
    v_mfma_f32_16x16x32_bf16 v[120:123], a[128:131], a[128:131], 0
    s_waitcnt lgkmcnt(2)
    v_mfma_f32_16x16x32_bf16 v[100:103], a[168:171], a[132:135], 0
    v_mfma_f32_16x16x32_bf16 v[124:127], a[132:135], a[132:135], 0
    s_waitcnt lgkmcnt(1)
    v_mfma_f32_16x16x32_bf16 v[96:99], a[168:171], a[136:139], v[96:99]
    v_mfma_f32_16x16x32_bf16 v[120:123], a[136:139], a[136:139], v[120:123]
    s_waitcnt lgkmcnt(0)
    v_mfma_f32_16x16x32_bf16 v[100:103], a[168:171], a[140:143], v[100:103]
    v_mfma_f32_16x16x32_bf16 v[124:127], a[140:143], a[140:143], v[124:127]
    s_mov_b32 s1, 1
    s_mov_b64 exec, 0
    s_cmp_eq_u32 s44, 0
    s_cbranch_scc1 Lpad_d0
    s_cmp_eq_u32 s44, 1
    s_cbranch_scc1 Lpad_d1
    s_cmp_eq_u32 s44, 2
    s_cbranch_scc1 Lpad_d2
    s_branch Lpad_s0
Lret_d:
    s_mov_b64 exec, -1
    s_waitcnt vmcnt(6)
    ds_read_b128 a[144:147], v28 offset:16384
    ds_read_b128 a[148:151], v28 offset:18432
    ds_read_b128 a[152:155], v29 offset:16384
    ds_read_b128 a[156:159], v29 offset:18432
    s_waitcnt lgkmcnt(3)
    v_mfma_f32_16x16x32_bf16 v[96:99], a[168:171], a[144:147], v[96:99]
    v_mfma_f32_16x16x32_bf16 v[120:123], a[144:147], a[144:147], v[120:123]
    s_waitcnt lgkmcnt(2)
    v_mfma_f32_16x16x32_bf16 v[100:103], a[168:171], a[148:151], v[100:103]
    v_mfma_f32_16x16x32_bf16 v[124:127], a[148:151], a[148:151], v[124:127]
    s_waitcnt lgkmcnt(1)
    v_mfma_f32_16x16x32_bf16 v[96:99], a[168:171], a[152:155], v[96:99]
    v_mfma_f32_16x16x32_bf16 v[120:123], a[152:155], a[152:155], v[120:123]
    s_waitcnt lgkmcnt(0)
    v_mfma_f32_16x16x32_bf16 v[100:103], a[168:171], a[156:159], v[100:103]
    v_mfma_f32_16x16x32_bf16 v[124:127], a[156:159], a[156:159], v[124:127]
    v_lshrrev_b32_e64 v5, 3, v1
    v_lshlrev_b32 v5, 2, v5
    s_bitcmp1_b32 s46, 0
    s_cselect_b32 s48, 0, 0xbc800000
    ds_bpermute_b32 v8, v5, v96 offset:0
    ds_bpermute_b32 v9, v5, v96 offset:32
    s_nop 0
    ds_bpermute_b32 v12, v5, v100 offset:0
    ds_bpermute_b32 v33, v5, v100 offset:32
    v_lshlrev_b32 v4, 3, v2
    v_mov_b32 v10, 2130706432
    v_mov_b32_e64 v98, v100
    v_cndmask_b32 v4, v10, v4, s[94:95]
    v_cndmask_b32 v120, v120, v121, s[88:89]
    v_cndmask_b32 v120, v120, v122, s[90:91]
    v_cndmask_b32 v97, v120, v123, s[92:93]
    v_cndmask_b32 v124, v124, v125, s[88:89]
    v_cndmask_b32 v124, v124, v126, s[90:91]
    v_cndmask_b32 v99, v124, v127, s[92:93]
    s_add_u32 s54, s71, s70
    s_and_b32 s55, s80, 1
    s_cselect_b64 vcc, -1, 0
    s_lshl_b32 s55, s55, 4
    s_lshl3_add_u32 s54, s55, s54
    v_cndmask_b32 v96, v96, v98, vcc
    v_cndmask_b32 v97, v97, v99, vcc
    s_add_u32 s55, s81, s70
    v_lshlrev_b32 v15, 4, v1
    s_waitcnt lgkmcnt(3)
    v_mul_f32 v8, s48, v8
    s_waitcnt lgkmcnt(2)
    v_mul_f32 v9, s48, v9
    s_waitcnt lgkmcnt(1)
    v_mul_f32 v12, s48, v12
    s_waitcnt lgkmcnt(0)
    v_mul_f32_e64 v33, s48, v33
    buffer_store_dwordx2 v[96:97], v4, s[32:35], s54 offen sc1
    s_lshl_b32 s58, s45, 2
    s_and_b32 s49, s80, 2
    s_add_u32 s58, s58, s49
    s_lshr_b32 s49, s44, 1
    s_add_u32 s58, s58, s49
    s_lshl_b32 s58, s58, 7
    s_add_u32 s58, s58, 10502144
    ds_read_b128 v[96:99], v32 offset:0
    ds_read_b128 v[112:115], v32 offset:16384
    ds_read_b128 v[100:103], v32 offset:1024
    ds_read_b128 v[116:119], v32 offset:17408
    ds_read_b128 v[104:107], v32 offset:2048
    ds_read_b128 v[120:123], v32 offset:18432
    ds_read_b128 v[108:111], v32 offset:3072
    ds_read_b128 v[124:127], v32 offset:19456
    s_add_u32 m0, s64, 49152
    s_xor_b32 s65, s65, 512
    buffer_load_dwordx4 v16, s[20:23], s65 offen offset:0 lds
    s_waitcnt lgkmcnt(6)
    v_perm_b32 v4, v112, v96, s18
    v_perm_b32 v112, v112, v96, s19
    v_perm_b32 v5, v113, v97, s18
    v_perm_b32 v113, v113, v97, s19
    v_perm_b32 v6, v114, v98, s18
    v_perm_b32 v114, v114, v98, s19
    v_perm_b32 v7, v115, v99, s18
    v_perm_b32 v115, v115, v99, s19
    v_dot2_f32_bf16 v4, v4, s16, v8
    v_dot2_f32_bf16 v112, v112, s16, v8
    v_dot2_f32_bf16 v5, v5, s16, v8
    v_dot2_f32_bf16 v113, v113, s16, v8
    v_dot2_f32_bf16 v6, v6, s16, v8
    v_dot2_f32_bf16 v114, v114, s16, v8
    v_dot2_f32_bf16 v7, v7, s16, v8
    v_dot2_f32_bf16 v115, v115, s16, v8
    v_cvt_pk_bf16_f32 v96, v4, v112
    v_cvt_pk_bf16_f32 v97, v5, v113
    v_cvt_pk_bf16_f32 v98, v6, v114
    v_cvt_pk_bf16_f32 v99, v7, v115
    ds_write_b128 v32, v[96:99] offset:0
    s_add_u32 s68, s68, 1
    s_and_b32 s68, s68, 3
    s_or_b32 s68, s68, 4
    buffer_load_dwordx4 v17, s[20:23], s65 offen offset:1024 lds
    s_waitcnt lgkmcnt(5)
    v_perm_b32 v4, v116, v100, s18
    v_perm_b32 v116, v116, v100, s19
    v_perm_b32 v5, v117, v101, s18
    v_perm_b32 v117, v117, v101, s19
    v_perm_b32 v6, v118, v102, s18
    v_perm_b32 v118, v118, v102, s19
    v_perm_b32 v7, v119, v103, s18
    v_perm_b32 v119, v119, v103, s19
    v_dot2_f32_bf16 v4, v4, s16, v9
    v_dot2_f32_bf16 v116, v116, s16, v9
    v_dot2_f32_bf16 v5, v5, s16, v9
    v_dot2_f32_bf16 v117, v117, s16, v9
    v_dot2_f32_bf16 v6, v6, s16, v9
    v_dot2_f32_bf16 v118, v118, s16, v9
    v_dot2_f32_bf16 v7, v7, s16, v9
    v_dot2_f32_bf16 v119, v119, s16, v9
    v_cvt_pk_bf16_f32 v100, v4, v116
    v_cvt_pk_bf16_f32 v101, v5, v117
    v_cvt_pk_bf16_f32 v102, v6, v118
    v_cvt_pk_bf16_f32 v103, v7, v119
    ds_write_b128 v32, v[100:103] offset:1024
    buffer_load_dwordx4 v18, s[20:23], s65 offen offset:2048 lds
    s_waitcnt lgkmcnt(4)
    v_perm_b32 v4, v120, v104, s18
    v_perm_b32 v120, v120, v104, s19
    v_perm_b32 v5, v121, v105, s18
    v_perm_b32 v121, v121, v105, s19
    v_perm_b32 v6, v122, v106, s18
    v_perm_b32 v122, v122, v106, s19
    v_perm_b32 v7, v123, v107, s18
    v_perm_b32 v123, v123, v107, s19
    v_dot2_f32_bf16 v4, v4, s16, v12
    v_dot2_f32_bf16 v120, v120, s16, v12
    v_dot2_f32_bf16 v5, v5, s16, v12
    v_dot2_f32_bf16 v121, v121, s16, v12
    v_dot2_f32_bf16 v6, v6, s16, v12
    v_dot2_f32_bf16 v122, v122, s16, v12
    v_dot2_f32_bf16 v7, v7, s16, v12
    v_dot2_f32_bf16 v123, v123, s16, v12
    v_cvt_pk_bf16_f32 v104, v4, v120
    v_cvt_pk_bf16_f32 v105, v5, v121
    v_cvt_pk_bf16_f32 v106, v6, v122
    v_cvt_pk_bf16_f32 v107, v7, v123
    ds_write_b128 v32, v[104:107] offset:2048
    buffer_load_dwordx4 v19, s[20:23], s65 offen offset:3072 lds
    s_waitcnt lgkmcnt(3)
    v_perm_b32 v4, v124, v108, s18
    v_perm_b32 v124, v124, v108, s19
    v_perm_b32 v5, v125, v109, s18
    v_perm_b32 v125, v125, v109, s19
    v_perm_b32 v6, v126, v110, s18
    v_perm_b32 v126, v126, v110, s19
    v_perm_b32 v7, v127, v111, s18
    v_perm_b32 v127, v127, v111, s19
    v_dot2_f32_bf16 v4, v4, s16, v33
    v_dot2_f32_bf16 v124, v124, s16, v33
    v_dot2_f32_bf16 v5, v5, s16, v33
    v_dot2_f32_bf16 v125, v125, s16, v33
    v_dot2_f32_bf16 v6, v6, s16, v33
    v_dot2_f32_bf16 v126, v126, s16, v33
    v_dot2_f32_bf16 v7, v7, s16, v33
    v_dot2_f32_bf16 v127, v127, s16, v33
    v_cvt_pk_bf16_f32 v108, v4, v124
    v_cvt_pk_bf16_f32 v109, v5, v125
    v_cvt_pk_bf16_f32 v110, v6, v126
    v_cvt_pk_bf16_f32 v111, v7, v127
    ds_write_b128 v32, v[108:111] offset:3072
    ds_read_b128 v[64:67], v30 offset:0
    ds_read_b128 v[68:71], v30 offset:16384
    ds_read_b128 v[72:75], v30 offset:2048
    ds_read_b128 v[76:79], v30 offset:18432
    s_waitcnt lgkmcnt(4)
    s_waitcnt vmcnt(9)
    s_barrier
    ds_read_b128 v[48:51], v26 offset:0
    ds_read_b128 v[52:55], v26 offset:2048
    ds_read_b128 v[56:59], v26 offset:4096
    s_waitcnt lgkmcnt(2)
    v_mfma_f32_16x16x32_bf16 v[128:131], v[48:51], v[64:67], 0
    ds_read_b128 v[60:63], v26 offset:6144
    ds_read_b128 v[80:83], v31 offset:0
    v_mfma_f32_16x16x32_bf16 v[132:135], v[48:51], v[68:71], 0
    s_add_u32 m0, s64, 98304
    s_mul_i32 s66, s69, s15
    v_mfma_f32_16x16x32_bf16 v[136:139], v[48:51], v[72:75], 0
    buffer_load_dwordx4 v20, s[24:27], s66 offen offset:0 lds
    v_mfma_f32_16x16x32_bf16 v[140:143], v[48:51], v[76:79], 0
    ds_read_b128 v[84:87], v31 offset:16384
    s_waitcnt lgkmcnt(4)
    v_mfma_f32_16x16x32_bf16 v[156:159], v[52:55], v[76:79], 0
    ds_read_b128 v[48:51], v26 offset:8192
    ds_read_b128 v[88:91], v31 offset:2048
    v_mfma_f32_16x16x32_bf16 v[152:155], v[52:55], v[72:75], 0
    ds_read_b128 v[92:95], v31 offset:18432
    ds_read_b128 a[192:195], v244 offset:0
    v_mfma_f32_16x16x32_bf16 v[148:151], v[52:55], v[68:71], 0
    buffer_load_dwordx4 v21, s[24:27], s66 offen offset:1024 lds
    v_mfma_f32_16x16x32_bf16 v[144:147], v[52:55], v[64:67], 0
    ds_read_b128 a[196:199], v245 offset:0
    s_waitcnt lgkmcnt(8)
    v_mfma_f32_16x16x32_bf16 v[160:163], v[56:59], v[64:67], 0
    ds_read_b128 v[52:55], v26 offset:10240
    ds_read_b128 a[200:203], v242 offset:2048
    v_mfma_f32_16x16x32_bf16 v[164:167], v[56:59], v[68:71], 0
    ds_read_b128 a[204:207], v243 offset:2048
    ds_read_b128 a[208:211], v242 offset:4096
    v_mfma_f32_16x16x32_bf16 v[168:171], v[56:59], v[72:75], 0
    buffer_load_dwordx4 v20, s[28:31], s66 offen offset:2048 lds
    v_mfma_f32_16x16x32_bf16 v[172:175], v[56:59], v[76:79], 0
    ds_read_b128 a[212:215], v243 offset:4096
    s_waitcnt lgkmcnt(12)
    v_mfma_f32_16x16x32_bf16 v[188:191], v[60:63], v[76:79], 0
    ds_read_b128 v[56:59], v26 offset:12288
    ds_read_b128 a[216:219], v242 offset:6144
    v_mfma_f32_16x16x32_bf16 v[184:187], v[60:63], v[72:75], 0
    ds_read_b128 a[220:223], v243 offset:6144
    v_mfma_f32_16x16x32_bf16 v[180:183], v[60:63], v[68:71], 0
    buffer_load_dwordx4 v21, s[28:31], s66 offen offset:3072 lds
    v_mfma_f32_16x16x32_bf16 v[176:179], v[60:63], v[64:67], 0
    s_waitcnt lgkmcnt(12)
    v_mfma_f32_16x16x32_bf16 v[192:195], v[48:51], v[64:67], 0
    ds_read_b128 v[60:63], v26 offset:14336
    v_mfma_f32_16x16x32_bf16 v[196:199], v[48:51], v[68:71], 0
    s_add_u32 m0, s64, 114688
    s_add_u32 s66, s66, s67
    v_mfma_f32_16x16x32_bf16 v[200:203], v[48:51], v[72:75], 0
    buffer_load_dwordx4 v20, s[24:27], s66 offen offset:0 lds
    v_mfma_f32_16x16x32_bf16 v[204:207], v[48:51], v[76:79], 0
    s_waitcnt lgkmcnt(8)
    v_mfma_f32_16x16x32_bf16 v[220:223], v[52:55], v[76:79], 0
    ds_read_b128 v[48:51], v27 offset:0
    v_mfma_f32_16x16x32_bf16 v[216:219], v[52:55], v[72:75], 0
    s_add_u32 s69, s69, 1
    s_and_b32 s69, s69, 3
    s_or_b32 s69, s69, 4
    v_mfma_f32_16x16x32_bf16 v[212:215], v[52:55], v[68:71], 0
    buffer_load_dwordx4 v21, s[24:27], s66 offen offset:1024 lds
    v_mfma_f32_16x16x32_bf16 v[208:211], v[52:55], v[64:67], 0
    s_waitcnt lgkmcnt(4)
    v_mfma_f32_16x16x32_bf16 v[224:227], v[56:59], v[64:67], 0
    ds_read_b128 v[52:55], v27 offset:2048
    v_mfma_f32_16x16x32_bf16 v[228:231], v[56:59], v[68:71], 0
    v_mfma_f32_16x16x32_bf16 v[232:235], v[56:59], v[72:75], 0
    buffer_load_dwordx4 v20, s[28:31], s66 offen offset:2048 lds
    v_mfma_f32_16x16x32_bf16 v[236:239], v[56:59], v[76:79], 0
    s_waitcnt lgkmcnt(2)
    v_mfma_f32_16x16x32_bf16 v[252:255], v[60:63], v[76:79], 0
    ds_read_b128 v[56:59], v27 offset:4096
    v_mfma_f32_16x16x32_bf16 v[248:251], v[60:63], v[72:75], 0
    v_mfma_f32_16x16x32_bf16 v[244:247], v[60:63], v[68:71], 0
    buffer_load_dwordx4 v21, s[28:31], s66 offen offset:3072 lds
    v_mfma_f32_16x16x32_bf16 v[240:243], v[60:63], v[64:67], 0
    s_waitcnt lgkmcnt(2)
    v_mfma_f32_16x16x32_bf16 v[128:131], v[48:51], v[80:83], v[128:131]
    ds_read_b128 v[60:63], v27 offset:6144
    s_load_dword s4, s[76:77], 0
    v_mfma_f32_16x16x32_bf16 v[132:135], v[48:51], v[84:87], v[132:135]
    v_mfma_f32_16x16x32_bf16 v[136:139], v[48:51], v[88:91], v[136:139]
    v_mfma_f32_16x16x32_bf16 v[140:143], v[48:51], v[92:95], v[140:143]
    s_waitcnt lgkmcnt(2)
    v_mfma_f32_16x16x32_bf16 v[156:159], v[52:55], v[92:95], v[156:159]
    ds_read_b128 v[48:51], v27 offset:8192
    v_mfma_f32_16x16x32_bf16 v[152:155], v[52:55], v[88:91], v[152:155]
    v_mfma_f32_16x16x32_bf16 v[148:151], v[52:55], v[84:87], v[148:151]
    v_mfma_f32_16x16x32_bf16 v[144:147], v[52:55], v[80:83], v[144:147]
    s_waitcnt lgkmcnt(2)
    v_mfma_f32_16x16x32_bf16 v[160:163], v[56:59], v[80:83], v[160:163]
    ds_read_b128 v[52:55], v27 offset:10240
    v_mfma_f32_16x16x32_bf16 v[164:167], v[56:59], v[84:87], v[164:167]
    v_mfma_f32_16x16x32_bf16 v[168:171], v[56:59], v[88:91], v[168:171]
    v_mfma_f32_16x16x32_bf16 v[172:175], v[56:59], v[92:95], v[172:175]
    s_waitcnt lgkmcnt(2)
    v_mfma_f32_16x16x32_bf16 v[188:191], v[60:63], v[92:95], v[188:191]
    ds_read_b128 v[56:59], v27 offset:12288
    v_mfma_f32_16x16x32_bf16 v[184:187], v[60:63], v[88:91], v[184:187]
    v_mfma_f32_16x16x32_bf16 v[180:183], v[60:63], v[84:87], v[180:183]
    v_mfma_f32_16x16x32_bf16 v[176:179], v[60:63], v[80:83], v[176:179]
    s_waitcnt vmcnt(8)
    s_waitcnt lgkmcnt(2)
    v_mfma_f32_16x16x32_bf16 v[192:195], v[48:51], v[80:83], v[192:195]
    ds_read_b128 v[60:63], v27 offset:14336
    ds_read_b128 v[96:99], v32 offset:32768
    v_mfma_f32_16x16x32_bf16 v[196:199], v[48:51], v[84:87], v[196:199]
    ds_read_b128 v[112:115], v32 offset:49152
    ds_read_b128 v[100:103], v32 offset:33792
    v_mfma_f32_16x16x32_bf16 v[200:203], v[48:51], v[88:91], v[200:203]
    ds_read_b128 v[116:119], v32 offset:50176
    ds_read_b128 v[104:107], v32 offset:34816
    v_mfma_f32_16x16x32_bf16 v[204:207], v[48:51], v[92:95], v[204:207]
    ds_read_b128 v[120:123], v32 offset:51200
    s_waitcnt lgkmcnt(8)
    v_mfma_f32_16x16x32_bf16 v[220:223], v[52:55], v[92:95], v[220:223]
    ds_read_b128 v[108:111], v32 offset:35840
    ds_read_b128 v[124:127], v32 offset:52224
    v_mfma_f32_16x16x32_bf16 v[216:219], v[52:55], v[88:91], v[216:219]
    v_mfma_f32_16x16x32_bf16 v[212:215], v[52:55], v[84:87], v[212:215]
    v_mfma_f32_16x16x32_bf16 v[208:211], v[52:55], v[80:83], v[208:211]
    s_waitcnt lgkmcnt(9)
    v_mfma_f32_16x16x32_bf16 v[224:227], v[56:59], v[80:83], v[224:227]
    v_mfma_f32_16x16x32_bf16 v[228:231], v[56:59], v[84:87], v[228:231]
    v_mfma_f32_16x16x32_bf16 v[232:235], v[56:59], v[88:91], v[232:235]
    v_mfma_f32_16x16x32_bf16 v[236:239], v[56:59], v[92:95], v[236:239]
    s_waitcnt lgkmcnt(8)
    v_mfma_f32_16x16x32_bf16 v[252:255], v[60:63], v[92:95], v[252:255]
    v_mfma_f32_16x16x32_bf16 v[248:251], v[60:63], v[88:91], v[248:251]
    v_mfma_f32_16x16x32_bf16 v[244:247], v[60:63], v[84:87], v[244:247]
    v_mfma_f32_16x16x32_bf16 v[240:243], v[60:63], v[80:83], v[240:243]
    s_waitcnt lgkmcnt(6)
    v_perm_b32 v4, v112, v96, s18
    v_perm_b32 v112, v112, v96, s19
    v_perm_b32 v5, v113, v97, s18
    v_perm_b32 v113, v113, v97, s19
    v_perm_b32 v6, v114, v98, s18
    v_perm_b32 v114, v114, v98, s19
    v_perm_b32 v7, v115, v99, s18
    v_perm_b32 v115, v115, v99, s19
    v_dot2_f32_bf16 v4, v4, s16, v8
    v_dot2_f32_bf16 v112, v112, s16, v8
    v_dot2_f32_bf16 v5, v5, s16, v8
    v_dot2_f32_bf16 v113, v113, s16, v8
    v_dot2_f32_bf16 v6, v6, s16, v8
    v_dot2_f32_bf16 v114, v114, s16, v8
    v_dot2_f32_bf16 v7, v7, s16, v8
    v_dot2_f32_bf16 v115, v115, s16, v8
    v_cvt_pk_bf16_f32 v96, v4, v112
    v_cvt_pk_bf16_f32 v97, v5, v113
    v_cvt_pk_bf16_f32 v98, v6, v114
    v_cvt_pk_bf16_f32 v99, v7, v115
    ds_write_b128 v32, v[96:99] offset:32768
    s_waitcnt lgkmcnt(5)
    v_perm_b32 v4, v116, v100, s18
    v_perm_b32 v116, v116, v100, s19
    v_perm_b32 v5, v117, v101, s18
    v_perm_b32 v117, v117, v101, s19
    v_perm_b32 v6, v118, v102, s18
    v_perm_b32 v118, v118, v102, s19
    v_perm_b32 v7, v119, v103, s18
    v_perm_b32 v119, v119, v103, s19
    v_dot2_f32_bf16 v4, v4, s16, v9
    v_dot2_f32_bf16 v116, v116, s16, v9
    v_dot2_f32_bf16 v5, v5, s16, v9
    v_dot2_f32_bf16 v117, v117, s16, v9
    v_dot2_f32_bf16 v6, v6, s16, v9
    v_dot2_f32_bf16 v118, v118, s16, v9
    v_dot2_f32_bf16 v7, v7, s16, v9
    v_dot2_f32_bf16 v119, v119, s16, v9
    v_cvt_pk_bf16_f32 v100, v4, v116
    v_cvt_pk_bf16_f32 v101, v5, v117
    v_cvt_pk_bf16_f32 v102, v6, v118
    v_cvt_pk_bf16_f32 v103, v7, v119
    ds_write_b128 v32, v[100:103] offset:33792
    s_waitcnt lgkmcnt(4)
    v_perm_b32 v4, v120, v104, s18
    v_perm_b32 v120, v120, v104, s19
    v_perm_b32 v5, v121, v105, s18
    v_perm_b32 v121, v121, v105, s19
    v_perm_b32 v6, v122, v106, s18
    v_perm_b32 v122, v122, v106, s19
    v_perm_b32 v7, v123, v107, s18
    v_perm_b32 v123, v123, v107, s19
    v_dot2_f32_bf16 v4, v4, s16, v12
    v_dot2_f32_bf16 v120, v120, s16, v12
    v_dot2_f32_bf16 v5, v5, s16, v12
    v_dot2_f32_bf16 v121, v121, s16, v12
    v_dot2_f32_bf16 v6, v6, s16, v12
    v_dot2_f32_bf16 v122, v122, s16, v12
    v_dot2_f32_bf16 v7, v7, s16, v12
    v_dot2_f32_bf16 v123, v123, s16, v12
    v_cvt_pk_bf16_f32 v104, v4, v120
    v_cvt_pk_bf16_f32 v105, v5, v121
    v_cvt_pk_bf16_f32 v106, v6, v122
    v_cvt_pk_bf16_f32 v107, v7, v123
    ds_write_b128 v32, v[104:107] offset:34816
    s_waitcnt lgkmcnt(3)
    v_perm_b32 v4, v124, v108, s18
    v_perm_b32 v124, v124, v108, s19
    v_perm_b32 v5, v125, v109, s18
    v_perm_b32 v125, v125, v109, s19
    v_perm_b32 v6, v126, v110, s18
    v_perm_b32 v126, v126, v110, s19
    v_perm_b32 v7, v127, v111, s18
    v_perm_b32 v127, v127, v111, s19
    v_dot2_f32_bf16 v4, v4, s16, v33
    v_dot2_f32_bf16 v124, v124, s16, v33
    v_dot2_f32_bf16 v5, v5, s16, v33
    v_dot2_f32_bf16 v125, v125, s16, v33
    v_dot2_f32_bf16 v6, v6, s16, v33
    v_dot2_f32_bf16 v126, v126, s16, v33
    v_dot2_f32_bf16 v7, v7, s16, v33
    v_dot2_f32_bf16 v127, v127, s16, v33
    v_cvt_pk_bf16_f32 v108, v4, v124
    v_cvt_pk_bf16_f32 v109, v5, v125
    v_cvt_pk_bf16_f32 v110, v6, v126
    v_cvt_pk_bf16_f32 v111, v7, v127
    ds_write_b128 v32, v[108:111] offset:35840
    s_waitcnt vmcnt(0)
    ds_read_b128 v[64:67], v30 offset:32768
    ds_read_b128 v[68:71], v30 offset:49152
    ds_read_b128 v[72:75], v30 offset:34816
    ds_read_b128 v[76:79], v30 offset:51200
    s_waitcnt lgkmcnt(4)
    s_waitcnt lgkmcnt(0)
    s_cmp_ge_u32 s4, 8
    s_cbranch_scc0 Ldi_slow
Ldi_ok:
    s_barrier
    ds_read_b128 v[48:51], v26 offset:32768
    ds_read_b128 v[52:55], v26 offset:34816
    ds_read_b128 v[56:59], v26 offset:36864
    s_atomic_add s87, s[78:79], s56
    s_waitcnt lgkmcnt(2)
    v_mfma_f32_16x16x32_bf16 v[128:131], v[48:51], v[64:67], v[128:131]
    ds_read_b128 v[60:63], v26 offset:38912
    ds_read_b128 v[80:83], v31 offset:32768
    v_mfma_f32_16x16x32_bf16 v[132:135], v[48:51], v[68:71], v[132:135]
    s_add_u32 m0, s64, 0
    s_lshl_b32 s65, s68, 7
    v_mfma_f32_16x16x32_bf16 v[136:139], v[48:51], v[72:75], v[136:139]
    buffer_load_dwordx4 v16, s[20:23], s65 offen offset:0 lds
    v_mfma_f32_16x16x32_bf16 v[140:143], v[48:51], v[76:79], v[140:143]
    ds_read_b128 v[84:87], v31 offset:49152
    s_waitcnt lgkmcnt(4)
    v_mfma_f32_16x16x32_bf16 v[156:159], v[52:55], v[76:79], v[156:159]
    ds_read_b128 v[48:51], v26 offset:40960
    ds_read_b128 v[88:91], v31 offset:34816
    v_mfma_f32_16x16x32_bf16 v[152:155], v[52:55], v[72:75], v[152:155]
    ds_read_b128 v[92:95], v31 offset:51200
    v_mfma_f32_16x16x32_bf16 v[148:151], v[52:55], v[68:71], v[148:151]
    buffer_load_dwordx4 v17, s[20:23], s65 offen offset:1024 lds
    v_mfma_f32_16x16x32_bf16 v[144:147], v[52:55], v[64:67], v[144:147]
    s_waitcnt lgkmcnt(6)
    v_mfma_f32_16x16x32_bf16 v[160:163], v[56:59], v[64:67], v[160:163]
    ds_read_b128 v[52:55], v26 offset:43008
    v_mfma_f32_16x16x32_bf16 v[164:167], v[56:59], v[68:71], v[164:167]
    v_mfma_f32_16x16x32_bf16 v[168:171], v[56:59], v[72:75], v[168:171]
    buffer_load_dwordx4 v18, s[20:23], s65 offen offset:2048 lds
    v_mfma_f32_16x16x32_bf16 v[172:175], v[56:59], v[76:79], v[172:175]
    s_waitcnt lgkmcnt(6)
    v_mfma_f32_16x16x32_bf16 v[188:191], v[60:63], v[76:79], v[188:191]
    ds_read_b128 v[56:59], v26 offset:45056
    v_mfma_f32_16x16x32_bf16 v[184:187], v[60:63], v[72:75], v[184:187]
    v_mfma_f32_16x16x32_bf16 v[180:183], v[60:63], v[68:71], v[180:183]
    buffer_load_dwordx4 v19, s[20:23], s65 offen offset:3072 lds
    v_mfma_f32_16x16x32_bf16 v[176:179], v[60:63], v[64:67], v[176:179]
    s_waitcnt lgkmcnt(4)
    v_mfma_f32_16x16x32_bf16 v[192:195], v[48:51], v[64:67], v[192:195]
    ds_read_b128 v[60:63], v26 offset:47104
    v_mfma_f32_16x16x32_bf16 v[196:199], v[48:51], v[68:71], v[196:199]
    s_add_u32 m0, s64, 16384
    s_xor_b32 s65, s65, 512
    v_mfma_f32_16x16x32_bf16 v[200:203], v[48:51], v[72:75], v[200:203]
    buffer_load_dwordx4 v16, s[20:23], s65 offen offset:0 lds
    v_mfma_f32_16x16x32_bf16 v[204:207], v[48:51], v[76:79], v[204:207]
    s_waitcnt lgkmcnt(2)
    v_mfma_f32_16x16x32_bf16 v[220:223], v[52:55], v[76:79], v[220:223]
    ds_read_b128 v[48:51], v27 offset:32768
    v_mfma_f32_16x16x32_bf16 v[216:219], v[52:55], v[72:75], v[216:219]
    s_add_u32 s68, s68, 1
    s_and_b32 s68, s68, 3
    s_or_b32 s68, s68, 4
    v_mfma_f32_16x16x32_bf16 v[212:215], v[52:55], v[68:71], v[212:215]
    buffer_load_dwordx4 v17, s[20:23], s65 offen offset:1024 lds
    v_mfma_f32_16x16x32_bf16 v[208:211], v[52:55], v[64:67], v[208:211]
    s_waitcnt lgkmcnt(2)
    v_mfma_f32_16x16x32_bf16 v[224:227], v[56:59], v[64:67], v[224:227]
    ds_read_b128 v[52:55], v27 offset:34816
    v_mfma_f32_16x16x32_bf16 v[228:231], v[56:59], v[68:71], v[228:231]
    v_mfma_f32_16x16x32_bf16 v[232:235], v[56:59], v[72:75], v[232:235]
    buffer_load_dwordx4 v18, s[20:23], s65 offen offset:2048 lds
    v_mfma_f32_16x16x32_bf16 v[236:239], v[56:59], v[76:79], v[236:239]
    s_waitcnt lgkmcnt(2)
    v_mfma_f32_16x16x32_bf16 v[252:255], v[60:63], v[76:79], v[252:255]
    ds_read_b128 v[56:59], v27 offset:36864
    v_mfma_f32_16x16x32_bf16 v[248:251], v[60:63], v[72:75], v[248:251]
    v_mfma_f32_16x16x32_bf16 v[244:247], v[60:63], v[68:71], v[244:247]
    buffer_load_dwordx4 v19, s[20:23], s65 offen offset:3072 lds
    v_mfma_f32_16x16x32_bf16 v[240:243], v[60:63], v[64:67], v[240:243]
    s_waitcnt lgkmcnt(2)
    v_mfma_f32_16x16x32_bf16 v[128:131], v[48:51], v[80:83], v[128:131]
    ds_read_b128 v[60:63], v27 offset:38912
    v_mfma_f32_16x16x32_bf16 v[132:135], v[48:51], v[84:87], v[132:135]
    s_add_u32 m0, s64, 65536
    s_mul_i32 s66, s69, s15
    v_mfma_f32_16x16x32_bf16 v[136:139], v[48:51], v[88:91], v[136:139]
    buffer_load_dwordx4 v20, s[24:27], s66 offen offset:0 lds
    v_mfma_f32_16x16x32_bf16 v[140:143], v[48:51], v[92:95], v[140:143]
    s_waitcnt lgkmcnt(2)
    v_mfma_f32_16x16x32_bf16 v[156:159], v[52:55], v[92:95], v[156:159]
    ds_read_b128 v[48:51], v27 offset:40960
    v_mfma_f32_16x16x32_bf16 v[152:155], v[52:55], v[88:91], v[152:155]
    v_mfma_f32_16x16x32_bf16 v[148:151], v[52:55], v[84:87], v[148:151]
    buffer_load_dwordx4 v21, s[24:27], s66 offen offset:1024 lds
    v_mfma_f32_16x16x32_bf16 v[144:147], v[52:55], v[80:83], v[144:147]
    s_waitcnt lgkmcnt(2)
    v_mfma_f32_16x16x32_bf16 v[160:163], v[56:59], v[80:83], v[160:163]
    ds_read_b128 v[52:55], v27 offset:43008
    v_mfma_f32_16x16x32_bf16 v[164:167], v[56:59], v[84:87], v[164:167]
    v_mfma_f32_16x16x32_bf16 v[168:171], v[56:59], v[88:91], v[168:171]
    buffer_load_dwordx4 v20, s[28:31], s66 offen offset:2048 lds
    v_mfma_f32_16x16x32_bf16 v[172:175], v[56:59], v[92:95], v[172:175]
    s_waitcnt lgkmcnt(2)
    v_mfma_f32_16x16x32_bf16 v[188:191], v[60:63], v[92:95], v[188:191]
    ds_read_b128 v[56:59], v27 offset:45056
    v_mfma_f32_16x16x32_bf16 v[184:187], v[60:63], v[88:91], v[184:187]
    v_mfma_f32_16x16x32_bf16 v[180:183], v[60:63], v[84:87], v[180:183]
    buffer_load_dwordx4 v21, s[28:31], s66 offen offset:3072 lds
    v_mfma_f32_16x16x32_bf16 v[176:179], v[60:63], v[80:83], v[176:179]
    s_waitcnt vmcnt(4)
    s_waitcnt lgkmcnt(2)
    v_mfma_f32_16x16x32_bf16 v[192:195], v[48:51], v[80:83], v[192:195]
    ds_read_b128 v[60:63], v27 offset:47104
    ds_read_b128 v[96:99], v32 offset:0
    v_mfma_f32_16x16x32_bf16 v[196:199], v[48:51], v[84:87], v[196:199]
    s_add_u32 m0, s64, 81920
    s_add_u32 s66, s66, s67
    v_mfma_f32_16x16x32_bf16 v[200:203], v[48:51], v[88:91], v[200:203]
    buffer_load_dwordx4 v20, s[24:27], s66 offen offset:0 lds
    v_mfma_f32_16x16x32_bf16 v[204:207], v[48:51], v[92:95], v[204:207]
    ds_read_b128 v[112:115], v32 offset:16384
    s_waitcnt lgkmcnt(4)
    v_mfma_f32_16x16x32_bf16 v[220:223], v[52:55], v[92:95], v[220:223]
    ds_read_b128 v[100:103], v32 offset:1024
    ds_read_b128 v[116:119], v32 offset:17408
Lpad_d0:
    s_cbranch_execz Lret_d
    v_mfma_f32_16x16x32_bf16 v[216:219], v[52:55], v[88:91], v[216:219]
    s_add_u32 s69, s69, 1
    s_and_b32 s69, s69, 3
    s_or_b32 s69, s69, 4
    v_mfma_f32_16x16x32_bf16 v[212:215], v[52:55], v[84:87], v[212:215]
    buffer_load_dwordx4 v21, s[24:27], s66 offen offset:1024 lds
    v_mfma_f32_16x16x32_bf16 v[208:211], v[52:55], v[80:83], v[208:211]
    ds_read_b128 v[104:107], v32 offset:2048
    s_waitcnt lgkmcnt(6)
    v_mfma_f32_16x16x32_bf16 v[224:227], v[56:59], v[80:83], v[224:227]
    ds_read_b128 v[120:123], v32 offset:18432
    ds_read_b128 v[108:111], v32 offset:3072
    v_mfma_f32_16x16x32_bf16 v[228:231], v[56:59], v[84:87], v[228:231]
    ds_read_b128 v[124:127], v32 offset:19456
    v_mfma_f32_16x16x32_bf16 v[232:235], v[56:59], v[88:91], v[232:235]
    buffer_load_dwordx4 v20, s[28:31], s66 offen offset:2048 lds
    v_mfma_f32_16x16x32_bf16 v[236:239], v[56:59], v[92:95], v[236:239]
    s_waitcnt lgkmcnt(8)
    v_mfma_f32_16x16x32_bf16 v[252:255], v[60:63], v[92:95], v[252:255]
    v_mfma_f32_16x16x32_bf16 v[248:251], v[60:63], v[88:91], v[248:251]
    v_mfma_f32_16x16x32_bf16 v[244:247], v[60:63], v[84:87], v[244:247]
    buffer_load_dwordx4 v21, s[28:31], s66 offen offset:3072 lds
    v_mfma_f32_16x16x32_bf16 v[240:243], v[60:63], v[80:83], v[240:243]
    s_waitcnt lgkmcnt(6)
    v_perm_b32 v4, v112, v96, s18
    v_perm_b32 v112, v112, v96, s19
    v_perm_b32 v5, v113, v97, s18
    v_perm_b32 v113, v113, v97, s19
    v_perm_b32 v6, v114, v98, s18
    v_perm_b32 v114, v114, v98, s19
    v_perm_b32 v7, v115, v99, s18
    v_perm_b32 v115, v115, v99, s19
    v_dot2_f32_bf16 v4, v4, s16, v8
    v_dot2_f32_bf16 v112, v112, s16, v8
    v_dot2_f32_bf16 v5, v5, s16, v8
    v_dot2_f32_bf16 v113, v113, s16, v8
    v_dot2_f32_bf16 v6, v6, s16, v8
    v_dot2_f32_bf16 v114, v114, s16, v8
    v_dot2_f32_bf16 v7, v7, s16, v8
    v_dot2_f32_bf16 v115, v115, s16, v8
    v_cvt_pk_bf16_f32 v96, v4, v112
    v_cvt_pk_bf16_f32 v97, v5, v113
    v_cvt_pk_bf16_f32 v98, v6, v114
    v_cvt_pk_bf16_f32 v99, v7, v115
    ds_write_b128 v32, v[96:99] offset:0
    s_waitcnt lgkmcnt(5)
    v_perm_b32 v4, v116, v100, s18
    v_perm_b32 v116, v116, v100, s19
    v_perm_b32 v5, v117, v101, s18
    v_perm_b32 v117, v117, v101, s19
    v_perm_b32 v6, v118, v102, s18
    v_perm_b32 v118, v118, v102, s19
    v_perm_b32 v7, v119, v103, s18
    v_perm_b32 v119, v119, v103, s19
    v_dot2_f32_bf16 v4, v4, s16, v9
    v_dot2_f32_bf16 v116, v116, s16, v9
    v_dot2_f32_bf16 v5, v5, s16, v9
    v_dot2_f32_bf16 v117, v117, s16, v9
    v_dot2_f32_bf16 v6, v6, s16, v9
    v_dot2_f32_bf16 v118, v118, s16, v9
    v_dot2_f32_bf16 v7, v7, s16, v9
    v_dot2_f32_bf16 v119, v119, s16, v9
    v_cvt_pk_bf16_f32 v100, v4, v116
    v_cvt_pk_bf16_f32 v101, v5, v117
    v_cvt_pk_bf16_f32 v102, v6, v118
    v_cvt_pk_bf16_f32 v103, v7, v119
    ds_write_b128 v32, v[100:103] offset:1024
    s_waitcnt lgkmcnt(4)
    v_perm_b32 v4, v120, v104, s18
    v_perm_b32 v120, v120, v104, s19
    v_perm_b32 v5, v121, v105, s18
    v_perm_b32 v121, v121, v105, s19
    v_perm_b32 v6, v122, v106, s18
    v_perm_b32 v122, v122, v106, s19
    v_perm_b32 v7, v123, v107, s18
    v_perm_b32 v123, v123, v107, s19
    v_dot2_f32_bf16 v4, v4, s16, v12
    v_dot2_f32_bf16 v120, v120, s16, v12
    v_dot2_f32_bf16 v5, v5, s16, v12
    v_dot2_f32_bf16 v121, v121, s16, v12
    v_dot2_f32_bf16 v6, v6, s16, v12
    v_dot2_f32_bf16 v122, v122, s16, v12
    v_dot2_f32_bf16 v7, v7, s16, v12
    v_dot2_f32_bf16 v123, v123, s16, v12
    v_cvt_pk_bf16_f32 v104, v4, v120
    v_cvt_pk_bf16_f32 v105, v5, v121
    v_cvt_pk_bf16_f32 v106, v6, v122
    v_cvt_pk_bf16_f32 v107, v7, v123
    ds_write_b128 v32, v[104:107] offset:2048
    s_waitcnt lgkmcnt(3)
    v_perm_b32 v4, v124, v108, s18
    v_perm_b32 v124, v124, v108, s19
    v_perm_b32 v5, v125, v109, s18
    v_perm_b32 v125, v125, v109, s19
    v_perm_b32 v6, v126, v110, s18
    v_perm_b32 v126, v126, v110, s19
    v_perm_b32 v7, v127, v111, s18
    v_perm_b32 v127, v127, v111, s19
    v_dot2_f32_bf16 v4, v4, s16, v33
    v_dot2_f32_bf16 v124, v124, s16, v33
    v_dot2_f32_bf16 v5, v5, s16, v33
    v_dot2_f32_bf16 v125, v125, s16, v33
    v_dot2_f32_bf16 v6, v6, s16, v33
    v_dot2_f32_bf16 v126, v126, s16, v33
    v_dot2_f32_bf16 v7, v7, s16, v33
    v_dot2_f32_bf16 v127, v127, s16, v33
    v_cvt_pk_bf16_f32 v108, v4, v124
    v_cvt_pk_bf16_f32 v109, v5, v125
    v_cvt_pk_bf16_f32 v110, v6, v126
    v_cvt_pk_bf16_f32 v111, v7, v127
    ds_write_b128 v32, v[108:111] offset:3072
    s_waitcnt vmcnt(0)
    ds_read_b128 v[64:67], v30 offset:0
    ds_read_b128 v[68:71], v30 offset:16384
    ds_read_b128 v[72:75], v30 offset:2048
    ds_read_b128 v[76:79], v30 offset:18432
    s_waitcnt lgkmcnt(4)
    s_barrier
    ds_read_b128 v[48:51], v26 offset:0
    ds_read_b128 v[52:55], v26 offset:2048
    ds_read_b128 v[56:59], v26 offset:4096
    s_waitcnt lgkmcnt(2)
    v_mfma_f32_16x16x32_bf16 v[128:131], v[48:51], v[64:67], v[128:131]
    ds_read_b128 v[60:63], v26 offset:6144
    ds_read_b128 v[80:83], v31 offset:0
    v_mfma_f32_16x16x32_bf16 v[132:135], v[48:51], v[68:71], v[132:135]
    s_add_u32 m0, s64, 32768
    s_lshl_b32 s65, s68, 7
    v_mfma_f32_16x16x32_bf16 v[136:139], v[48:51], v[72:75], v[136:139]
    buffer_load_dwordx4 v16, s[20:23], s65 offen offset:0 lds
    v_mfma_f32_16x16x32_bf16 v[140:143], v[48:51], v[76:79], v[140:143]
    ds_read_b128 v[84:87], v31 offset:16384
    s_waitcnt lgkmcnt(4)
    v_mfma_f32_16x16x32_bf16 v[156:159], v[52:55], v[76:79], v[156:159]
    ds_read_b128 v[48:51], v26 offset:8192
    ds_read_b128 v[88:91], v31 offset:2048
    v_mfma_f32_16x16x32_bf16 v[152:155], v[52:55], v[72:75], v[152:155]
    ds_read_b128 v[92:95], v31 offset:18432
    v_mfma_f32_16x16x32_bf16 v[148:151], v[52:55], v[68:71], v[148:151]
    buffer_load_dwordx4 v17, s[20:23], s65 offen offset:1024 lds
    v_mfma_f32_16x16x32_bf16 v[144:147], v[52:55], v[64:67], v[144:147]
    s_waitcnt lgkmcnt(6)
    v_mfma_f32_16x16x32_bf16 v[160:163], v[56:59], v[64:67], v[160:163]
    ds_read_b128 v[52:55], v26 offset:10240
    v_mfma_f32_16x16x32_bf16 v[164:167], v[56:59], v[68:71], v[164:167]
    v_mfma_f32_16x16x32_bf16 v[168:171], v[56:59], v[72:75], v[168:171]
    buffer_load_dwordx4 v18, s[20:23], s65 offen offset:2048 lds
    v_mfma_f32_16x16x32_bf16 v[172:175], v[56:59], v[76:79], v[172:175]
    s_waitcnt lgkmcnt(6)
    v_mfma_f32_16x16x32_bf16 v[188:191], v[60:63], v[76:79], v[188:191]
    ds_read_b128 v[56:59], v26 offset:12288
    v_mfma_f32_16x16x32_bf16 v[184:187], v[60:63], v[72:75], v[184:187]
    v_mfma_f32_16x16x32_bf16 v[180:183], v[60:63], v[68:71], v[180:183]
    buffer_load_dwordx4 v19, s[20:23], s65 offen offset:3072 lds
    v_mfma_f32_16x16x32_bf16 v[176:179], v[60:63], v[64:67], v[176:179]
    s_waitcnt lgkmcnt(4)
    v_mfma_f32_16x16x32_bf16 v[192:195], v[48:51], v[64:67], v[192:195]
    ds_read_b128 v[60:63], v26 offset:14336
    s_load_dword s4, s[78:79], s58 glc
    v_mfma_f32_16x16x32_bf16 v[196:199], v[48:51], v[68:71], v[196:199]
    s_add_u32 m0, s64, 49152
    s_xor_b32 s65, s65, 512
    v_mfma_f32_16x16x32_bf16 v[200:203], v[48:51], v[72:75], v[200:203]
    buffer_load_dwordx4 v16, s[20:23], s65 offen offset:0 lds
    v_mfma_f32_16x16x32_bf16 v[204:207], v[48:51], v[76:79], v[204:207]
    s_waitcnt lgkmcnt(2)
    v_mfma_f32_16x16x32_bf16 v[220:223], v[52:55], v[76:79], v[220:223]
    ds_read_b128 v[48:51], v27 offset:0
    v_mfma_f32_16x16x32_bf16 v[216:219], v[52:55], v[72:75], v[216:219]
    s_add_u32 s68, s68, 1
    s_and_b32 s68, s68, 3
    s_or_b32 s68, s68, 4
    v_mfma_f32_16x16x32_bf16 v[212:215], v[52:55], v[68:71], v[212:215]
    buffer_load_dwordx4 v17, s[20:23], s65 offen offset:1024 lds
    v_mfma_f32_16x16x32_bf16 v[208:211], v[52:55], v[64:67], v[208:211]
    s_waitcnt lgkmcnt(2)
    v_mfma_f32_16x16x32_bf16 v[224:227], v[56:59], v[64:67], v[224:227]
    ds_read_b128 v[52:55], v27 offset:2048
    v_mfma_f32_16x16x32_bf16 v[228:231], v[56:59], v[68:71], v[228:231]
    v_mfma_f32_16x16x32_bf16 v[232:235], v[56:59], v[72:75], v[232:235]
    buffer_load_dwordx4 v18, s[20:23], s65 offen offset:2048 lds
    v_mfma_f32_16x16x32_bf16 v[236:239], v[56:59], v[76:79], v[236:239]
    s_waitcnt lgkmcnt(2)
    v_mfma_f32_16x16x32_bf16 v[252:255], v[60:63], v[76:79], v[252:255]
    ds_read_b128 v[56:59], v27 offset:4096
    v_mfma_f32_16x16x32_bf16 v[248:251], v[60:63], v[72:75], v[248:251]
    v_mfma_f32_16x16x32_bf16 v[244:247], v[60:63], v[68:71], v[244:247]
    buffer_load_dwordx4 v19, s[20:23], s65 offen offset:3072 lds
    v_mfma_f32_16x16x32_bf16 v[240:243], v[60:63], v[64:67], v[240:243]
    s_waitcnt lgkmcnt(2)
    v_mfma_f32_16x16x32_bf16 v[128:131], v[48:51], v[80:83], v[128:131]
    ds_read_b128 v[60:63], v27 offset:6144
    v_mfma_f32_16x16x32_bf16 v[132:135], v[48:51], v[84:87], v[132:135]
    s_add_u32 m0, s64, 98304
    s_mul_i32 s66, s69, s15
    v_mfma_f32_16x16x32_bf16 v[136:139], v[48:51], v[88:91], v[136:139]
    buffer_load_dwordx4 v20, s[24:27], s66 offen offset:0 lds
    v_mfma_f32_16x16x32_bf16 v[140:143], v[48:51], v[92:95], v[140:143]
    s_waitcnt lgkmcnt(2)
    v_mfma_f32_16x16x32_bf16 v[156:159], v[52:55], v[92:95], v[156:159]
    ds_read_b128 v[48:51], v27 offset:8192
    v_mfma_f32_16x16x32_bf16 v[152:155], v[52:55], v[88:91], v[152:155]
    v_mfma_f32_16x16x32_bf16 v[148:151], v[52:55], v[84:87], v[148:151]
    buffer_load_dwordx4 v21, s[24:27], s66 offen offset:1024 lds
    v_mfma_f32_16x16x32_bf16 v[144:147], v[52:55], v[80:83], v[144:147]
    s_waitcnt lgkmcnt(2)
    v_mfma_f32_16x16x32_bf16 v[160:163], v[56:59], v[80:83], v[160:163]
    ds_read_b128 v[52:55], v27 offset:10240
    v_mfma_f32_16x16x32_bf16 v[164:167], v[56:59], v[84:87], v[164:167]
    v_mfma_f32_16x16x32_bf16 v[168:171], v[56:59], v[88:91], v[168:171]
    buffer_load_dwordx4 v20, s[28:31], s66 offen offset:2048 lds
    v_mfma_f32_16x16x32_bf16 v[172:175], v[56:59], v[92:95], v[172:175]
    s_waitcnt lgkmcnt(2)
    v_mfma_f32_16x16x32_bf16 v[188:191], v[60:63], v[92:95], v[188:191]
    ds_read_b128 v[56:59], v27 offset:12288
    v_mfma_f32_16x16x32_bf16 v[184:187], v[60:63], v[88:91], v[184:187]
    v_mfma_f32_16x16x32_bf16 v[180:183], v[60:63], v[84:87], v[180:183]
    buffer_load_dwordx4 v21, s[28:31], s66 offen offset:3072 lds
    v_mfma_f32_16x16x32_bf16 v[176:179], v[60:63], v[80:83], v[176:179]
    s_waitcnt vmcnt(4)
    s_waitcnt lgkmcnt(2)
    v_mfma_f32_16x16x32_bf16 v[192:195], v[48:51], v[80:83], v[192:195]
    ds_read_b128 v[60:63], v27 offset:14336
    ds_read_b128 v[96:99], v32 offset:32768
    v_mfma_f32_16x16x32_bf16 v[196:199], v[48:51], v[84:87], v[196:199]
    s_add_u32 m0, s64, 114688
    s_add_u32 s66, s66, s67
    v_mfma_f32_16x16x32_bf16 v[200:203], v[48:51], v[88:91], v[200:203]
    buffer_load_dwordx4 v20, s[24:27], s66 offen offset:0 lds
    v_mfma_f32_16x16x32_bf16 v[204:207], v[48:51], v[92:95], v[204:207]
    ds_read_b128 v[112:115], v32 offset:49152
    s_waitcnt lgkmcnt(4)
    v_mfma_f32_16x16x32_bf16 v[220:223], v[52:55], v[92:95], v[220:223]
    ds_read_b128 v[100:103], v32 offset:33792
    ds_read_b128 v[116:119], v32 offset:50176
    v_mfma_f32_16x16x32_bf16 v[216:219], v[52:55], v[88:91], v[216:219]
    s_add_u32 s69, s69, 1
    s_and_b32 s69, s69, 3
    s_or_b32 s69, s69, 4
    v_mfma_f32_16x16x32_bf16 v[212:215], v[52:55], v[84:87], v[212:215]
    buffer_load_dwordx4 v21, s[24:27], s66 offen offset:1024 lds
    v_mfma_f32_16x16x32_bf16 v[208:211], v[52:55], v[80:83], v[208:211]
    ds_read_b128 v[104:107], v32 offset:34816
    s_waitcnt lgkmcnt(6)
    v_mfma_f32_16x16x32_bf16 v[224:227], v[56:59], v[80:83], v[224:227]
    ds_read_b128 v[120:123], v32 offset:51200
    ds_read_b128 v[108:111], v32 offset:35840
    v_mfma_f32_16x16x32_bf16 v[228:231], v[56:59], v[84:87], v[228:231]
    ds_read_b128 v[124:127], v32 offset:52224
    v_mfma_f32_16x16x32_bf16 v[232:235], v[56:59], v[88:91], v[232:235]
    buffer_load_dwordx4 v20, s[28:31], s66 offen offset:2048 lds
    v_mfma_f32_16x16x32_bf16 v[236:239], v[56:59], v[92:95], v[236:239]
    s_waitcnt lgkmcnt(8)
    v_mfma_f32_16x16x32_bf16 v[252:255], v[60:63], v[92:95], v[252:255]
    v_mfma_f32_16x16x32_bf16 v[248:251], v[60:63], v[88:91], v[248:251]
    v_mfma_f32_16x16x32_bf16 v[244:247], v[60:63], v[84:87], v[244:247]
    buffer_load_dwordx4 v21, s[28:31], s66 offen offset:3072 lds
    v_mfma_f32_16x16x32_bf16 v[240:243], v[60:63], v[80:83], v[240:243]
    s_waitcnt lgkmcnt(0)
    s_cmp_ge_u32 s4, 8
    s_cbranch_scc0 Lds_slow
Lds_ok:
    buffer_load_dwordx4 a[160:163], v15, s[32:35], s71 offen sc1
    s_add_u32 m0, s64, 131072
    s_lshl_b32 s5, s8, 5
    buffer_load_dwordx4 v22, s[36:39], s5 offen offset:0 lds
    v_perm_b32 v4, v112, v96, s18
    v_perm_b32 v112, v112, v96, s19
    v_perm_b32 v5, v113, v97, s18
    v_perm_b32 v113, v113, v97, s19
    v_perm_b32 v6, v114, v98, s18
    v_perm_b32 v114, v114, v98, s19
    v_perm_b32 v7, v115, v99, s18
    v_perm_b32 v115, v115, v99, s19
    v_dot2_f32_bf16 v4, v4, s16, v8
    v_dot2_f32_bf16 v112, v112, s16, v8
    v_dot2_f32_bf16 v5, v5, s16, v8
    v_dot2_f32_bf16 v113, v113, s16, v8
    v_dot2_f32_bf16 v6, v6, s16, v8
    v_dot2_f32_bf16 v114, v114, s16, v8
    v_dot2_f32_bf16 v7, v7, s16, v8
    v_dot2_f32_bf16 v115, v115, s16, v8
    v_cvt_pk_bf16_f32 v96, v4, v112
    v_cvt_pk_bf16_f32 v97, v5, v113
    v_cvt_pk_bf16_f32 v98, v6, v114
    v_cvt_pk_bf16_f32 v99, v7, v115
    ds_write_b128 v32, v[96:99] offset:32768
    buffer_load_dwordx4 v23, s[36:39], s5 offen offset:1024 lds
    v_perm_b32 v4, v116, v100, s18
    v_perm_b32 v116, v116, v100, s19
    v_perm_b32 v5, v117, v101, s18
    v_perm_b32 v117, v117, v101, s19
    v_perm_b32 v6, v118, v102, s18
    v_perm_b32 v118, v118, v102, s19
    v_perm_b32 v7, v119, v103, s18
    v_perm_b32 v119, v119, v103, s19
    v_dot2_f32_bf16 v4, v4, s16, v9
    v_dot2_f32_bf16 v116, v116, s16, v9
    v_dot2_f32_bf16 v5, v5, s16, v9
    v_dot2_f32_bf16 v117, v117, s16, v9
    v_dot2_f32_bf16 v6, v6, s16, v9
    v_dot2_f32_bf16 v118, v118, s16, v9
    v_dot2_f32_bf16 v7, v7, s16, v9
    v_dot2_f32_bf16 v119, v119, s16, v9
    v_cvt_pk_bf16_f32 v100, v4, v116
    v_cvt_pk_bf16_f32 v101, v5, v117
    v_cvt_pk_bf16_f32 v102, v6, v118
    v_cvt_pk_bf16_f32 v103, v7, v119
    ds_write_b128 v32, v[100:103] offset:33792
    buffer_load_dwordx4 v24, s[36:39], s5 offen offset:2048 lds
    v_perm_b32 v4, v120, v104, s18
    v_perm_b32 v120, v120, v104, s19
    v_perm_b32 v5, v121, v105, s18
    v_perm_b32 v121, v121, v105, s19
    v_perm_b32 v6, v122, v106, s18
    v_perm_b32 v122, v122, v106, s19
    v_perm_b32 v7, v123, v107, s18
    v_perm_b32 v123, v123, v107, s19
    v_dot2_f32_bf16 v4, v4, s16, v12
    v_dot2_f32_bf16 v120, v120, s16, v12
    v_dot2_f32_bf16 v5, v5, s16, v12
    v_dot2_f32_bf16 v121, v121, s16, v12
    v_dot2_f32_bf16 v6, v6, s16, v12
    v_dot2_f32_bf16 v122, v122, s16, v12
    v_dot2_f32_bf16 v7, v7, s16, v12
    v_dot2_f32_bf16 v123, v123, s16, v12
    v_cvt_pk_bf16_f32 v104, v4, v120
    v_cvt_pk_bf16_f32 v105, v5, v121
    v_cvt_pk_bf16_f32 v106, v6, v122
    v_cvt_pk_bf16_f32 v107, v7, v123
    ds_write_b128 v32, v[104:107] offset:34816
    buffer_load_dwordx4 v25, s[36:39], s5 offen offset:3072 lds
    v_perm_b32 v4, v124, v108, s18
    v_perm_b32 v124, v124, v108, s19
    v_perm_b32 v5, v125, v109, s18
    v_perm_b32 v125, v125, v109, s19
    v_perm_b32 v6, v126, v110, s18
    v_perm_b32 v126, v126, v110, s19
    v_perm_b32 v7, v127, v111, s18
    v_perm_b32 v127, v127, v111, s19
    v_dot2_f32_bf16 v4, v4, s16, v33
    v_dot2_f32_bf16 v124, v124, s16, v33
    v_dot2_f32_bf16 v5, v5, s16, v33
    v_dot2_f32_bf16 v125, v125, s16, v33
    v_dot2_f32_bf16 v6, v6, s16, v33
    v_dot2_f32_bf16 v126, v126, s16, v33
    v_dot2_f32_bf16 v7, v7, s16, v33
    v_dot2_f32_bf16 v127, v127, s16, v33
    v_cvt_pk_bf16_f32 v108, v4, v124
    v_cvt_pk_bf16_f32 v109, v5, v125
    v_cvt_pk_bf16_f32 v110, v6, v126
    v_cvt_pk_bf16_f32 v111, v7, v127
    ds_write_b128 v32, v[108:111] offset:35840
    s_waitcnt vmcnt(5)
    ds_read_b128 v[64:67], v30 offset:32768
    ds_read_b128 v[68:71], v30 offset:49152
    ds_read_b128 v[72:75], v30 offset:34816
    ds_read_b128 v[76:79], v30 offset:51200
    s_waitcnt lgkmcnt(4)
    s_barrier
    ds_read_b128 v[48:51], v26 offset:32768
    ds_read_b128 v[52:55], v26 offset:34816
    ds_read_b128 v[56:59], v26 offset:36864
    s_waitcnt lgkmcnt(2)
    v_mfma_f32_16x16x32_bf16 v[128:131], v[48:51], v[64:67], v[128:131]
    ds_read_b128 v[60:63], v26 offset:38912
    ds_read_b128 v[80:83], v31 offset:32768
    v_mfma_f32_16x16x32_bf16 v[132:135], v[48:51], v[68:71], v[132:135]
    s_add_u32 m0, s64, 147456
    s_add_u32 s5, s5, 32768
    v_mfma_f32_16x16x32_bf16 v[136:139], v[48:51], v[72:75], v[136:139]
    buffer_load_dwordx4 v22, s[36:39], s5 offen offset:0 lds
    v_mfma_f32_16x16x32_bf16 v[140:143], v[48:51], v[76:79], v[140:143]
    ds_read_b128 v[84:87], v31 offset:49152
    s_waitcnt lgkmcnt(4)
    v_mfma_f32_16x16x32_bf16 v[156:159], v[52:55], v[76:79], v[156:159]
    ds_read_b128 v[48:51], v26 offset:40960
    ds_read_b128 v[88:91], v31 offset:34816
    v_mfma_f32_16x16x32_bf16 v[152:155], v[52:55], v[72:75], v[152:155]
    ds_read_b128 v[92:95], v31 offset:51200
    s_waitcnt vmcnt(5)
    v_accvgpr_read_b32 v96, a160
    v_mfma_f32_16x16x32_bf16 v[148:151], v[52:55], v[68:71], v[148:151]
    buffer_load_dwordx4 v23, s[36:39], s5 offen offset:1024 lds
    v_mfma_f32_16x16x32_bf16 v[144:147], v[52:55], v[64:67], v[144:147]
    v_accvgpr_read_b32 v97, a161
    s_waitcnt lgkmcnt(6)
    v_mfma_f32_16x16x32_bf16 v[160:163], v[56:59], v[64:67], v[160:163]
    ds_read_b128 v[52:55], v26 offset:43008
    v_accvgpr_read_b32 v98, a162
    v_mfma_f32_16x16x32_bf16 v[164:167], v[56:59], v[68:71], v[164:167]
    v_accvgpr_read_b32 v99, a163
    s_lshl_b32 s48, s44, 7
    v_mfma_f32_16x16x32_bf16 v[168:171], v[56:59], v[72:75], v[168:171]
    buffer_load_dwordx4 v24, s[36:39], s5 offen offset:2048 lds
    v_mfma_f32_16x16x32_bf16 v[172:175], v[56:59], v[76:79], v[172:175]
    s_add_u32 s48, s48, 16384
    s_waitcnt lgkmcnt(6)
    v_mfma_f32_16x16x32_bf16 v[188:191], v[60:63], v[76:79], v[188:191]
    ds_read_b128 v[56:59], v26 offset:45056
    v_permlane32_swap_b32 v96, v98
    v_mfma_f32_16x16x32_bf16 v[184:187], v[60:63], v[72:75], v[184:187]
    v_permlane32_swap_b32 v97, v99
    v_add_f32_e64 v100, v96, v98
    v_mfma_f32_16x16x32_bf16 v[180:183], v[60:63], v[68:71], v[180:183]
    buffer_load_dwordx4 v25, s[36:39], s5 offen offset:3072 lds
    v_mfma_f32_16x16x32_bf16 v[176:179], v[60:63], v[64:67], v[176:179]
    v_add_f32 v101, v97, v99
    s_waitcnt lgkmcnt(4)
    v_mfma_f32_16x16x32_bf16 v[192:195], v[48:51], v[64:67], v[192:195]
    ds_read_b128 v[60:63], v26 offset:47104
    v_add_f32_e64 v96, v96, v98
    v_mfma_f32_16x16x32_bf16 v[196:199], v[48:51], v[68:71], v[196:199]
    v_add_f32 v97, v97, v99
    v_lshrrev_b32 v14, 1, v3
    v_mfma_f32_16x16x32_bf16 v[200:203], v[48:51], v[72:75], v[200:203]
    v_lshl_add_u32 v14, v2, 1, v14
    v_permlane16_swap_b32 v96, v100
    v_mfma_f32_16x16x32_bf16 v[204:207], v[48:51], v[76:79], v[204:207]
    v_permlane16_swap_b32 v97, v101
    s_waitcnt lgkmcnt(2)
    v_mfma_f32_16x16x32_bf16 v[220:223], v[52:55], v[76:79], v[220:223]
    ds_read_b128 v[48:51], v27 offset:32768
    v_lshl_add_u32 v14, v14, 2, s48
    v_mfma_f32_16x16x32_bf16 v[216:219], v[52:55], v[72:75], v[216:219]
    v_add_f32 v96, v96, v100
    v_add_f32_e64 v97, v97, v101
    v_mfma_f32_16x16x32_bf16 v[212:215], v[52:55], v[68:71], v[212:215]
    v_mul_f32 v4, 0xbb000000, v96
    v_mul_f32 v97, 0x3b000000, v97
    v_mfma_f32_16x16x32_bf16 v[208:211], v[52:55], v[64:67], v[208:211]
    v_fma_f32 v97, -v4, v4, v97
    s_waitcnt lgkmcnt(2)
    v_mfma_f32_16x16x32_bf16 v[224:227], v[56:59], v[64:67], v[224:227]
    ds_read_b128 v[52:55], v27 offset:34816
    v_max_f32 v97, 0, v97
    v_mfma_f32_16x16x32_bf16 v[228:231], v[56:59], v[68:71], v[228:231]
    v_add_f32 v97, 0x3727c5ac, v97
    v_rsq_f32_e64 v7, v97
    v_mfma_f32_16x16x32_bf16 v[232:235], v[56:59], v[72:75], v[232:235]
    v_lshlrev_b32_e64 v15, 4, v3
    ds_write_b32 v14, v7
    v_mfma_f32_16x16x32_bf16 v[236:239], v[56:59], v[76:79], v[236:239]
    s_lshl_b32 s50, s45, 12
    s_waitcnt lgkmcnt(3)
    v_mfma_f32_16x16x32_bf16 v[252:255], v[60:63], v[76:79], v[252:255]
    ds_read_b128 v[56:59], v27 offset:36864
    s_lshl_b32 s49, s46, 11
    v_mfma_f32_16x16x32_bf16 v[248:251], v[60:63], v[72:75], v[248:251]
    s_add_u32 s50, s50, s49
    s_lshl_b32 s49, s44, 9
    v_mfma_f32_16x16x32_bf16 v[244:247], v[60:63], v[68:71], v[244:247]
    s_add_u32 s50, s50, s49
    v_mul_u32_u24 v16, 131072, v3
    v_mfma_f32_16x16x32_bf16 v[240:243], v[60:63], v[64:67], v[240:243]
    v_lshl_add_u32 v17, v2, 4, s50
    s_waitcnt lgkmcnt(3)
    v_mfma_f32_16x16x32_bf16 v[128:131], v[48:51], v[80:83], v[128:131]
    ds_read_b128 v[60:63], v27 offset:38912
    v_add_u32 v16, v16, v17
    v_mfma_f32_16x16x32_bf16 v[132:135], v[48:51], v[84:87], v[132:135]
    s_add_u32 m0, s64, 0
    s_lshl_b32 s5, s9, 5
    v_mfma_f32_16x16x32_bf16 v[136:139], v[48:51], v[88:91], v[136:139]
    buffer_load_dwordx4 v22, s[36:39], s5 offen offset:0 lds
    v_mfma_f32_16x16x32_bf16 v[140:143], v[48:51], v[92:95], v[140:143]
    s_lshr_b32 s60, s45, 2
    s_waitcnt lgkmcnt(3)
    v_mfma_f32_16x16x32_bf16 v[156:159], v[52:55], v[92:95], v[156:159]
    ds_read_b128 v[48:51], v27 offset:40960
    s_lshl_b32 s60, s60, 7
    v_mfma_f32_16x16x32_bf16 v[152:155], v[52:55], v[88:91], v[152:155]
    s_add_u32 s60, s60, s64
    s_add_u32 s60, s60, 10502148
    v_mfma_f32_16x16x32_bf16 v[148:151], v[52:55], v[84:87], v[148:151]
    buffer_load_dwordx4 v23, s[36:39], s5 offen offset:1024 lds
    v_mfma_f32_16x16x32_bf16 v[144:147], v[52:55], v[80:83], v[144:147]
    s_waitcnt lgkmcnt(2)
    v_mfma_f32_16x16x32_bf16 v[160:163], v[56:59], v[80:83], v[160:163]
    ds_read_b128 v[52:55], v27 offset:43008
    v_mfma_f32_16x16x32_bf16 v[164:167], v[56:59], v[84:87], v[164:167]
    v_mfma_f32_16x16x32_bf16 v[168:171], v[56:59], v[88:91], v[168:171]
    buffer_load_dwordx4 v24, s[36:39], s5 offen offset:2048 lds
    v_mfma_f32_16x16x32_bf16 v[172:175], v[56:59], v[92:95], v[172:175]
    s_waitcnt lgkmcnt(2)
    v_mfma_f32_16x16x32_bf16 v[188:191], v[60:63], v[92:95], v[188:191]
    ds_read_b128 v[56:59], v27 offset:45056
    v_mfma_f32_16x16x32_bf16 v[184:187], v[60:63], v[88:91], v[184:187]
    v_mfma_f32_16x16x32_bf16 v[180:183], v[60:63], v[84:87], v[180:183]
    buffer_load_dwordx4 v25, s[36:39], s5 offen offset:3072 lds
    v_mfma_f32_16x16x32_bf16 v[176:179], v[60:63], v[80:83], v[176:179]
    s_waitcnt lgkmcnt(2)
    v_mfma_f32_16x16x32_bf16 v[192:195], v[48:51], v[80:83], v[192:195]
    ds_read_b128 v[60:63], v27 offset:47104
    v_mfma_f32_16x16x32_bf16 v[196:199], v[48:51], v[84:87], v[196:199]
    s_add_u32 m0, s64, 65536
    s_add_u32 s5, s5, 32768
    v_mfma_f32_16x16x32_bf16 v[200:203], v[48:51], v[88:91], v[200:203]
    buffer_load_dwordx4 v22, s[36:39], s5 offen offset:0 lds
    v_mfma_f32_16x16x32_bf16 v[204:207], v[48:51], v[92:95], v[204:207]
    s_waitcnt lgkmcnt(2)
    v_mfma_f32_16x16x32_bf16 v[220:223], v[52:55], v[92:95], v[220:223]
    v_mfma_f32_16x16x32_bf16 v[216:219], v[52:55], v[88:91], v[216:219]
    v_mfma_f32_16x16x32_bf16 v[212:215], v[52:55], v[84:87], v[212:215]
    buffer_load_dwordx4 v23, s[36:39], s5 offen offset:1024 lds
    v_mfma_f32_16x16x32_bf16 v[208:211], v[52:55], v[80:83], v[208:211]
    s_waitcnt lgkmcnt(1)
    v_mfma_f32_16x16x32_bf16 v[224:227], v[56:59], v[80:83], v[224:227]
    v_mfma_f32_16x16x32_bf16 v[228:231], v[56:59], v[84:87], v[228:231]
    v_mfma_f32_16x16x32_bf16 v[232:235], v[56:59], v[88:91], v[232:235]
    buffer_load_dwordx4 v24, s[36:39], s5 offen offset:2048 lds
    v_mfma_f32_16x16x32_bf16 v[236:239], v[56:59], v[92:95], v[236:239]
    s_waitcnt lgkmcnt(0)
    s_barrier
    v_mfma_f32_16x16x32_bf16 v[252:255], v[60:63], v[92:95], v[252:255]
    ds_read_b128 v[64:67], v15 offset:16384
    ds_read_b128 v[68:71], v15 offset:16448
    v_mfma_f32_16x16x32_bf16 v[248:251], v[60:63], v[88:91], v[248:251]
    ds_read_b128 v[72:75], v15 offset:16512
    ds_read_b128 v[76:79], v15 offset:16576
    v_mfma_f32_16x16x32_bf16 v[244:247], v[60:63], v[84:87], v[244:247]
    buffer_load_dwordx4 v25, s[36:39], s5 offen offset:3072 lds
    v_mfma_f32_16x16x32_bf16 v[240:243], v[60:63], v[80:83], v[240:243]
    ds_read_b128 v[80:83], v15 offset:16640
    ds_read_b128 v[84:87], v15 offset:16704
    ds_read_b128 v[88:91], v15 offset:16768
    ds_read_b128 v[92:95], v15 offset:16832
    s_waitcnt lgkmcnt(7)
    v_pk_mul_f32 v[128:129], v[128:129], v[64:65]
    v_pk_mul_f32 v[130:131], v[130:131], v[66:67]
    s_waitcnt lgkmcnt(5)
    v_pk_mul_f32 v[160:161], v[160:161], v[72:73]
    v_pk_mul_f32 v[162:163], v[162:163], v[74:75]
    v_pk_mul_f32 v[136:137], v[136:137], v[64:65]
    v_pk_mul_f32 v[138:139], v[138:139], v[66:67]
    v_pk_mul_f32 v[168:169], v[168:169], v[72:73]
    v_pk_mul_f32 v[170:171], v[170:171], v[74:75]
    v_cvt_pk_bf16_f32 v96, v128, v160
    v_cvt_pk_bf16_f32 v97, v129, v161
    v_cvt_pk_bf16_f32 v98, v130, v162
    v_cvt_pk_bf16_f32 v99, v131, v163
    v_cvt_pk_bf16_f32 v100, v136, v168
    v_cvt_pk_bf16_f32 v101, v137, v169
    v_cvt_pk_bf16_f32 v102, v138, v170
    v_cvt_pk_bf16_f32 v103, v139, v171
    s_waitcnt lgkmcnt(0)
    s_nop 0
    v_pk_mul_f32 v[144:145], v[144:145], v[68:69]
    v_pk_mul_f32 v[146:147], v[146:147], v[70:71]
    v_pk_mul_f32 v[176:177], v[176:177], v[76:77]
    v_pk_mul_f32 v[178:179], v[178:179], v[78:79]
    v_pk_mul_f32 v[152:153], v[152:153], v[68:69]
    v_pk_mul_f32 v[154:155], v[154:155], v[70:71]
    v_pk_mul_f32 v[184:185], v[184:185], v[76:77]
    v_pk_mul_f32 v[186:187], v[186:187], v[78:79]
    v_cvt_pk_bf16_f32 v104, v144, v176
    v_cvt_pk_bf16_f32 v105, v145, v177
Lpad_d1:
    s_cbranch_execz Lret_d
    v_cvt_pk_bf16_f32 v106, v146, v178
    v_cvt_pk_bf16_f32 v107, v147, v179
    v_cvt_pk_bf16_f32 v108, v152, v184
    v_cvt_pk_bf16_f32 v109, v153, v185
    v_cvt_pk_bf16_f32 v110, v154, v186
    v_cvt_pk_bf16_f32 v111, v155, v187
    v_pk_mul_f32 v[192:193], v[192:193], v[80:81]
    v_pk_mul_f32 v[194:195], v[194:195], v[82:83]
    v_pk_mul_f32 v[224:225], v[224:225], v[88:89]
    v_pk_mul_f32 v[226:227], v[226:227], v[90:91]
    v_pk_mul_f32 v[200:201], v[200:201], v[80:81]
    v_pk_mul_f32 v[202:203], v[202:203], v[82:83]
    v_pk_mul_f32 v[232:233], v[232:233], v[88:89]
    v_pk_mul_f32 v[234:235], v[234:235], v[90:91]
    v_cvt_pk_bf16_f32 v112, v192, v224
    v_cvt_pk_bf16_f32 v113, v193, v225
    v_cvt_pk_bf16_f32 v114, v194, v226
    v_cvt_pk_bf16_f32 v115, v195, v227
    v_cvt_pk_bf16_f32 v116, v200, v232
    v_cvt_pk_bf16_f32 v117, v201, v233
    v_cvt_pk_bf16_f32 v118, v202, v234
    v_cvt_pk_bf16_f32 v119, v203, v235
    v_pk_mul_f32 v[208:209], v[208:209], v[84:85]
    v_pk_mul_f32 v[210:211], v[210:211], v[86:87]
    v_pk_mul_f32 v[240:241], v[240:241], v[92:93]
    v_pk_mul_f32 v[242:243], v[242:243], v[94:95]
    v_pk_mul_f32 v[216:217], v[216:217], v[84:85]
    v_pk_mul_f32 v[218:219], v[218:219], v[86:87]
    v_pk_mul_f32 v[248:249], v[248:249], v[92:93]
    v_pk_mul_f32 v[250:251], v[250:251], v[94:95]
    v_cvt_pk_bf16_f32 v120, v208, v240
    v_cvt_pk_bf16_f32 v121, v209, v241
    v_cvt_pk_bf16_f32 v122, v210, v242
    v_cvt_pk_bf16_f32 v123, v211, v243
    v_cvt_pk_bf16_f32 v124, v216, v248
    v_cvt_pk_bf16_f32 v125, v217, v249
    v_cvt_pk_bf16_f32 v126, v218, v250
    v_cvt_pk_bf16_f32 v127, v219, v251
    v_mfma_f32_16x16x32_bf16 v[128:131], a[192:195], v[96:99], 0
    v_mfma_f32_16x16x32_bf16 v[136:139], a[192:195], v[100:103], 0
    v_mfma_f32_16x16x32_bf16 v[144:147], a[192:195], v[112:115], 0
    v_mfma_f32_16x16x32_bf16 v[152:155], a[192:195], v[116:119], 0
    v_mfma_f32_16x16x32_bf16 v[128:131], a[196:199], v[104:107], v[128:131]
    v_mfma_f32_16x16x32_bf16 v[136:139], a[196:199], v[108:111], v[136:139]
    v_mfma_f32_16x16x32_bf16 v[144:147], a[196:199], v[120:123], v[144:147]
    v_mfma_f32_16x16x32_bf16 v[152:155], a[196:199], v[124:127], v[152:155]
    v_mfma_f32_16x16x32_bf16 v[160:163], a[200:203], v[96:99], 0
    v_mfma_f32_16x16x32_bf16 v[168:171], a[200:203], v[100:103], 0
    v_mfma_f32_16x16x32_bf16 v[176:179], a[200:203], v[112:115], 0
    s_nop 1
    v_cvt_pk_bf16_f32 v48, v128, v129
    v_cvt_pk_bf16_f32 v49, v136, v137
    v_mfma_f32_16x16x32_bf16 v[184:187], a[200:203], v[116:119], 0
    v_cvt_pk_bf16_f32 v50, v144, v145
    v_cvt_pk_bf16_f32 v51, v152, v153
    v_mfma_f32_16x16x32_bf16 v[160:163], a[204:207], v[104:107], v[160:163]
    s_mov_b32 s50, 7901184
    buffer_store_dwordx4 v[48:51], v16, s[32:35], s50 offen offset:0 sc1
    v_mfma_f32_16x16x32_bf16 v[168:171], a[204:207], v[108:111], v[168:171]
    v_cvt_pk_bf16_f32 v52, v130, v131
    v_cvt_pk_bf16_f32 v53, v138, v139
    v_mfma_f32_16x16x32_bf16 v[176:179], a[204:207], v[120:123], v[176:179]
    v_cvt_pk_bf16_f32 v54, v146, v147
    v_cvt_pk_bf16_f32 v55, v154, v155
    v_mfma_f32_16x16x32_bf16 v[184:187], a[204:207], v[124:127], v[184:187]
    s_mov_b32 s50, 7966720
    buffer_store_dwordx4 v[52:55], v16, s[32:35], s50 offen offset:0 sc1
    v_mfma_f32_16x16x32_bf16 v[192:195], a[208:211], v[96:99], 0
    v_mfma_f32_16x16x32_bf16 v[200:203], a[208:211], v[100:103], 0
    v_mfma_f32_16x16x32_bf16 v[208:211], a[208:211], v[112:115], 0
    v_cvt_pk_bf16_f32 v56, v160, v161
    v_cvt_pk_bf16_f32 v57, v168, v169
    v_mfma_f32_16x16x32_bf16 v[216:219], a[208:211], v[116:119], 0
    v_cvt_pk_bf16_f32 v58, v176, v177
    v_cvt_pk_bf16_f32 v59, v184, v185
    v_mfma_f32_16x16x32_bf16 v[192:195], a[212:215], v[104:107], v[192:195]
    s_mov_b32 s50, 8425472
    buffer_store_dwordx4 v[56:59], v16, s[32:35], s50 offen offset:0 sc1
    v_mfma_f32_16x16x32_bf16 v[200:203], a[212:215], v[108:111], v[200:203]
    v_cvt_pk_bf16_f32 v60, v162, v163
    v_cvt_pk_bf16_f32 v61, v170, v171
    v_mfma_f32_16x16x32_bf16 v[208:211], a[212:215], v[120:123], v[208:211]
    v_cvt_pk_bf16_f32 v62, v178, v179
    v_cvt_pk_bf16_f32 v63, v186, v187
    v_mfma_f32_16x16x32_bf16 v[216:219], a[212:215], v[124:127], v[216:219]
    s_mov_b32 s50, 8491008
    buffer_store_dwordx4 v[60:63], v16, s[32:35], s50 offen offset:0 sc1
    v_mfma_f32_16x16x32_bf16 v[224:227], a[216:219], v[96:99], 0
    v_mfma_f32_16x16x32_bf16 v[232:235], a[216:219], v[100:103], 0
    v_mfma_f32_16x16x32_bf16 v[240:243], a[216:219], v[112:115], 0
    v_cvt_pk_bf16_f32 v48, v192, v193
    v_cvt_pk_bf16_f32 v49, v200, v201
    v_mfma_f32_16x16x32_bf16 v[248:251], a[216:219], v[116:119], 0
    v_cvt_pk_bf16_f32 v50, v208, v209
    v_cvt_pk_bf16_f32 v51, v216, v217
    v_mfma_f32_16x16x32_bf16 v[224:227], a[220:223], v[104:107], v[224:227]
    s_mov_b32 s50, 8949760
    buffer_store_dwordx4 v[48:51], v16, s[32:35], s50 offen offset:0 sc1
    v_mfma_f32_16x16x32_bf16 v[232:235], a[220:223], v[108:111], v[232:235]
    v_cvt_pk_bf16_f32 v52, v194, v195
    v_cvt_pk_bf16_f32 v53, v202, v203
    v_mfma_f32_16x16x32_bf16 v[240:243], a[220:223], v[120:123], v[240:243]
    v_cvt_pk_bf16_f32 v54, v210, v211
    v_cvt_pk_bf16_f32 v55, v218, v219
    v_mfma_f32_16x16x32_bf16 v[248:251], a[220:223], v[124:127], v[248:251]
    s_mov_b32 s50, 9015296
    buffer_store_dwordx4 v[52:55], v16, s[32:35], s50 offen offset:0 sc1
    v_pk_mul_f32 v[132:133], v[132:133], v[64:65]
    v_pk_mul_f32 v[134:135], v[134:135], v[66:67]
    v_pk_mul_f32 v[164:165], v[164:165], v[72:73]
    v_pk_mul_f32 v[166:167], v[166:167], v[74:75]
    v_pk_mul_f32 v[140:141], v[140:141], v[64:65]
    v_pk_mul_f32 v[142:143], v[142:143], v[66:67]
    v_pk_mul_f32 v[172:173], v[172:173], v[72:73]
    v_pk_mul_f32 v[174:175], v[174:175], v[74:75]
    v_cvt_pk_bf16_f32 v96, v132, v164
    v_cvt_pk_bf16_f32 v97, v133, v165
    v_cvt_pk_bf16_f32 v98, v134, v166
    v_cvt_pk_bf16_f32 v99, v135, v167
    v_cvt_pk_bf16_f32 v100, v140, v172
    v_cvt_pk_bf16_f32 v101, v141, v173
    v_cvt_pk_bf16_f32 v102, v142, v174
    v_cvt_pk_bf16_f32 v103, v143, v175
    v_cvt_pk_bf16_f32 v56, v224, v225
    v_cvt_pk_bf16_f32 v57, v232, v233
    v_cvt_pk_bf16_f32 v58, v240, v241
    v_cvt_pk_bf16_f32 v59, v248, v249
    s_mov_b32 s50, 9474048
    buffer_store_dwordx4 v[56:59], v16, s[32:35], s50 offen offset:0 sc1
    v_pk_mul_f32 v[148:149], v[148:149], v[68:69]
    v_pk_mul_f32 v[150:151], v[150:151], v[70:71]
    v_pk_mul_f32 v[180:181], v[180:181], v[76:77]
    v_pk_mul_f32 v[182:183], v[182:183], v[78:79]
    v_pk_mul_f32 v[156:157], v[156:157], v[68:69]
    v_pk_mul_f32 v[158:159], v[158:159], v[70:71]
    v_pk_mul_f32 v[188:189], v[188:189], v[76:77]
    v_pk_mul_f32 v[190:191], v[190:191], v[78:79]
    v_cvt_pk_bf16_f32 v104, v148, v180
    v_cvt_pk_bf16_f32 v105, v149, v181
    v_cvt_pk_bf16_f32 v106, v150, v182
    v_cvt_pk_bf16_f32 v107, v151, v183
    v_cvt_pk_bf16_f32 v108, v156, v188
    v_cvt_pk_bf16_f32 v109, v157, v189
    v_cvt_pk_bf16_f32 v110, v158, v190
    v_cvt_pk_bf16_f32 v111, v159, v191
    v_cvt_pk_bf16_f32 v60, v226, v227
    v_cvt_pk_bf16_f32 v61, v234, v235
    v_cvt_pk_bf16_f32 v62, v242, v243
    v_cvt_pk_bf16_f32 v63, v250, v251
    s_mov_b32 s50, 9539584
    buffer_store_dwordx4 v[60:63], v16, s[32:35], s50 offen offset:0 sc1
    v_pk_mul_f32 v[196:197], v[196:197], v[80:81]
    v_pk_mul_f32 v[198:199], v[198:199], v[82:83]
    v_pk_mul_f32 v[228:229], v[228:229], v[88:89]
    v_pk_mul_f32 v[230:231], v[230:231], v[90:91]
    v_pk_mul_f32 v[204:205], v[204:205], v[80:81]
    v_pk_mul_f32 v[206:207], v[206:207], v[82:83]
    v_pk_mul_f32 v[236:237], v[236:237], v[88:89]
    v_pk_mul_f32 v[238:239], v[238:239], v[90:91]
    v_cvt_pk_bf16_f32 v112, v196, v228
    v_cvt_pk_bf16_f32 v113, v197, v229
    v_cvt_pk_bf16_f32 v114, v198, v230
    v_cvt_pk_bf16_f32 v115, v199, v231
    v_cvt_pk_bf16_f32 v116, v204, v236
    v_cvt_pk_bf16_f32 v117, v205, v237
    v_cvt_pk_bf16_f32 v118, v206, v238
    v_cvt_pk_bf16_f32 v119, v207, v239
    v_pk_mul_f32 v[212:213], v[212:213], v[84:85]
    v_pk_mul_f32 v[214:215], v[214:215], v[86:87]
    v_pk_mul_f32 v[244:245], v[244:245], v[92:93]
    v_pk_mul_f32 v[246:247], v[246:247], v[94:95]
    v_pk_mul_f32 v[220:221], v[220:221], v[84:85]
    v_pk_mul_f32 v[222:223], v[222:223], v[86:87]
    v_pk_mul_f32 v[252:253], v[252:253], v[92:93]
    v_pk_mul_f32 v[254:255], v[254:255], v[94:95]
    v_cvt_pk_bf16_f32 v120, v212, v244
    v_cvt_pk_bf16_f32 v121, v213, v245
    v_cvt_pk_bf16_f32 v122, v214, v246
    v_cvt_pk_bf16_f32 v123, v215, v247
    v_cvt_pk_bf16_f32 v124, v220, v252
    v_cvt_pk_bf16_f32 v125, v221, v253
    v_cvt_pk_bf16_f32 v126, v222, v254
    v_cvt_pk_bf16_f32 v127, v223, v255
    v_mfma_f32_16x16x32_bf16 v[132:135], a[192:195], v[96:99], 0
    v_mfma_f32_16x16x32_bf16 v[140:143], a[192:195], v[100:103], 0
    v_mfma_f32_16x16x32_bf16 v[148:151], a[192:195], v[112:115], 0
    v_mfma_f32_16x16x32_bf16 v[156:159], a[192:195], v[116:119], 0
    v_mfma_f32_16x16x32_bf16 v[132:135], a[196:199], v[104:107], v[132:135]
    v_mfma_f32_16x16x32_bf16 v[140:143], a[196:199], v[108:111], v[140:143]
    v_mfma_f32_16x16x32_bf16 v[148:151], a[196:199], v[120:123], v[148:151]
    v_mfma_f32_16x16x32_bf16 v[156:159], a[196:199], v[124:127], v[156:159]
    v_mfma_f32_16x16x32_bf16 v[164:167], a[200:203], v[96:99], 0
    v_mfma_f32_16x16x32_bf16 v[172:175], a[200:203], v[100:103], 0
    v_mfma_f32_16x16x32_bf16 v[180:183], a[200:203], v[112:115], 0
    s_nop 1
    v_cvt_pk_bf16_f32 v48, v132, v133
    v_cvt_pk_bf16_f32 v49, v140, v141
    v_mfma_f32_16x16x32_bf16 v[188:191], a[200:203], v[116:119], 0
    v_cvt_pk_bf16_f32 v50, v148, v149
    v_cvt_pk_bf16_f32 v51, v156, v157
    v_mfma_f32_16x16x32_bf16 v[164:167], a[204:207], v[104:107], v[164:167]
    s_mov_b32 s50, 7901184
    buffer_store_dwordx4 v[48:51], v16, s[32:35], s50 offen offset:256 sc1
    v_mfma_f32_16x16x32_bf16 v[172:175], a[204:207], v[108:111], v[172:175]
    v_cvt_pk_bf16_f32 v52, v134, v135
    v_cvt_pk_bf16_f32 v53, v142, v143
    v_mfma_f32_16x16x32_bf16 v[180:183], a[204:207], v[120:123], v[180:183]
    v_cvt_pk_bf16_f32 v54, v150, v151
    v_cvt_pk_bf16_f32 v55, v158, v159
    v_mfma_f32_16x16x32_bf16 v[188:191], a[204:207], v[124:127], v[188:191]
    s_mov_b32 s50, 7966720
    buffer_store_dwordx4 v[52:55], v16, s[32:35], s50 offen offset:256 sc1
    v_mfma_f32_16x16x32_bf16 v[196:199], a[208:211], v[96:99], 0
    v_mfma_f32_16x16x32_bf16 v[204:207], a[208:211], v[100:103], 0
    v_mfma_f32_16x16x32_bf16 v[212:215], a[208:211], v[112:115], 0
    v_cvt_pk_bf16_f32 v56, v164, v165
    v_cvt_pk_bf16_f32 v57, v172, v173
    v_mfma_f32_16x16x32_bf16 v[220:223], a[208:211], v[116:119], 0
    v_cvt_pk_bf16_f32 v58, v180, v181
    v_cvt_pk_bf16_f32 v59, v188, v189
    v_mfma_f32_16x16x32_bf16 v[196:199], a[212:215], v[104:107], v[196:199]
    s_mov_b32 s50, 8425472
    buffer_store_dwordx4 v[56:59], v16, s[32:35], s50 offen offset:256 sc1
    v_mfma_f32_16x16x32_bf16 v[204:207], a[212:215], v[108:111], v[204:207]
    v_cvt_pk_bf16_f32 v60, v166, v167
    v_cvt_pk_bf16_f32 v61, v174, v175
    v_mfma_f32_16x16x32_bf16 v[212:215], a[212:215], v[120:123], v[212:215]
    v_cvt_pk_bf16_f32 v62, v182, v183
    v_cvt_pk_bf16_f32 v63, v190, v191
    v_mfma_f32_16x16x32_bf16 v[220:223], a[212:215], v[124:127], v[220:223]
    s_mov_b32 s50, 8491008
    buffer_store_dwordx4 v[60:63], v16, s[32:35], s50 offen offset:256 sc1
    v_mfma_f32_16x16x32_bf16 v[228:231], a[216:219], v[96:99], 0
    v_mfma_f32_16x16x32_bf16 v[236:239], a[216:219], v[100:103], 0
    v_mfma_f32_16x16x32_bf16 v[244:247], a[216:219], v[112:115], 0
    v_cvt_pk_bf16_f32 v48, v196, v197
    v_cvt_pk_bf16_f32 v49, v204, v205
    v_mfma_f32_16x16x32_bf16 v[252:255], a[216:219], v[116:119], 0
    v_cvt_pk_bf16_f32 v50, v212, v213
    v_cvt_pk_bf16_f32 v51, v220, v221
    v_mfma_f32_16x16x32_bf16 v[228:231], a[220:223], v[104:107], v[228:231]
    s_mov_b32 s50, 8949760
    buffer_store_dwordx4 v[48:51], v16, s[32:35], s50 offen offset:256 sc1
    v_mfma_f32_16x16x32_bf16 v[236:239], a[220:223], v[108:111], v[236:239]
    v_cvt_pk_bf16_f32 v52, v198, v199
    v_cvt_pk_bf16_f32 v53, v206, v207
    v_mfma_f32_16x16x32_bf16 v[244:247], a[220:223], v[120:123], v[244:247]
    v_cvt_pk_bf16_f32 v54, v214, v215
    v_cvt_pk_bf16_f32 v55, v222, v223
    v_mfma_f32_16x16x32_bf16 v[252:255], a[220:223], v[124:127], v[252:255]
    s_mov_b32 s50, 9015296
    buffer_store_dwordx4 v[52:55], v16, s[32:35], s50 offen offset:256 sc1
    v_cvt_pk_bf16_f32 v56, v228, v229
    v_cvt_pk_bf16_f32 v57, v236, v237
    s_nop 0
    v_cvt_pk_bf16_f32 v58, v244, v245
    s_nop 1
    v_cvt_pk_bf16_f32 v59, v252, v253
    s_mov_b32 s50, 9474048
    buffer_store_dwordx4 v[56:59], v16, s[32:35], s50 offen offset:256 sc1
    v_cvt_pk_bf16_f32 v60, v230, v231
    v_cvt_pk_bf16_f32 v61, v238, v239
    v_cvt_pk_bf16_f32 v62, v246, v247
    v_cvt_pk_bf16_f32 v63, v254, v255
    s_mov_b32 s50, 9539584
    buffer_store_dwordx4 v[60:63], v16, s[32:35], s50 offen offset:256 sc1
    s_lshl_b32 s65, s6, 2
    s_add_u32 s65, s65, s44
    s_lshl_b32 s65, s65, 7
    s_add_u32 s65, s65, 10502148
    s_mov_b32 s86, 1048576
    s_lshr_b32 s48, s6, 1
    s_lshl_b32 s48, s48, 2
    s_add_u32 s48, s48, s44
    s_lshl_b32 s48, s48, 8
    s_add_u32 s63, s48, 10485760
    s_add_u32 s61, s48, 10485888
    s_waitcnt vmcnt(28)
    ds_read_b64_tr_b16 a[0:1], v42 offset:0
    ds_read_b64_tr_b16 a[2:3], v42 offset:2048
    ds_read_b64_tr_b16 a[4:5], v43 offset:0
    ds_read_b64_tr_b16 a[6:7], v43 offset:2048
    ds_read_b64_tr_b16 a[8:9], v44 offset:0
    ds_read_b64_tr_b16 a[10:11], v44 offset:2048
    ds_read_b64_tr_b16 a[12:13], v45 offset:0
    ds_read_b64_tr_b16 a[14:15], v45 offset:2048
    s_waitcnt vmcnt(24)
    ds_read_b64_tr_b16 a[16:17], v42 offset:16384
    ds_read_b64_tr_b16 a[18:19], v42 offset:18432
    ds_read_b64_tr_b16 a[20:21], v43 offset:16384
    ds_read_b64_tr_b16 a[22:23], v43 offset:18432
    ds_read_b64_tr_b16 a[24:25], v44 offset:16384
    ds_read_b64_tr_b16 a[26:27], v44 offset:18432
    ds_read_b64_tr_b16 a[28:29], v45 offset:16384
    ds_read_b64_tr_b16 a[30:31], v45 offset:18432
    s_waitcnt vmcnt(20)
    ds_read_b64_tr_b16 a[32:33], v34 offset:0
    ds_read_b64_tr_b16 a[34:35], v34 offset:2048
    ds_read_b64_tr_b16 a[36:37], v35 offset:0
    ds_read_b64_tr_b16 a[38:39], v35 offset:2048
    ds_read_b64_tr_b16 a[40:41], v36 offset:0
    ds_read_b64_tr_b16 a[42:43], v36 offset:2048
    ds_read_b64_tr_b16 a[44:45], v37 offset:0
    ds_read_b64_tr_b16 a[46:47], v37 offset:2048
    s_waitcnt vmcnt(16)
    ds_read_b64_tr_b16 a[48:49], v38 offset:0
    ds_read_b64_tr_b16 a[50:51], v38 offset:2048
    ds_read_b64_tr_b16 a[52:53], v39 offset:0
    ds_read_b64_tr_b16 a[54:55], v39 offset:2048
    ds_read_b64_tr_b16 a[56:57], v40 offset:0
    ds_read_b64_tr_b16 a[58:59], v40 offset:2048
    ds_read_b64_tr_b16 a[60:61], v41 offset:0
    ds_read_b64_tr_b16 a[62:63], v41 offset:2048
    v_lshlrev_b32 v7, 4, v1
    s_mul_i32 s50, s6, 229376
    s_mul_i32 s49, s44, 14336
    s_add_u32 s50, s50, s49
    s_and_b32 s48, s44, 2
    s_mul_i32 s49, s48, 57344
    s_add_u32 s49, s49, s50
    v_add_u32 v31, s49, v7
    s_xor_b32 s48, s48, 2
    s_mul_i32 s49, s48, 57344
    s_add_u32 s49, s49, s50
    v_add_u32_e64 v30, s49, v7
    v_add_u32 v32, 57344, v30
    v_add_u32 v33, 57344, v31
    v_add_u32 v7, 65536, v7
    v_add_u32_e64 v15, s64, v7
    v_xor_b32 v18, 4096, v15
    v_xor_b32 v20, 8192, v15
    v_xor_b32 v21, 12288, v15
    s_waitcnt lgkmcnt(0)
    s_add_u32 s88, s78, s60
    s_addc_u32 s89, s79, 0
    s_lshl_b32 s49, s7, 6
    s_sub_u32 s50, s49, 256
    s_sub_u32 s49, 193, s49
    s_cmp_ge_u32 s7, 4
    s_cselect_b32 s49, s50, s49
    s_cselect_b32 s51, 0, 63
    v_and_b32 v5, 31, v1
    v_lshrrev_b32_e64 v6, 5, v1
    v_lshl_add_u32 v5, v5, 1, s49
    v_add_u32_e64 v5, v5, v6
    s_mul_i32 s48, s47, 65536
    s_lshl_b32 s49, s44, 14
    s_add_u32 s48, s48, s49
    s_add_u32 s48, s48, 7929856
    v_cmp_gt_u32 vcc, 0x100, v5
    v_and_b32 v6, 1, v5
    v_lshrrev_b32 v5, 1, v5
    v_lshl_add_u32 v5, v6, 7, v5
    v_lshl_add_u32 v5, v5, 4, s48
    s_and_b32 s48, s44, 1
    s_lshl_b32 s48, s48, 5
    v_cndmask_b32 v26, v10, v5, vcc
    s_xor_b32 s48, s48, s51
    v_xor_b32_e64 v4, s48, v2
    v_add_u32 v27, 3072, v26
    v_add_u32 v28, 6144, v26
    v_add_u32 v29, 9216, v26
    v_and_b32 v6, 1, v4
    v_lshrrev_b32 v4, 1, v4
    v_lshl_add_u32 v4, v6, 5, v4
    v_lshl_add_u32 v4, v3, 6, v4
    v_lshlrev_b32_e64 v4, 4, v4
    v_add_u32 v14, 65536, v4
    v_xor_b32 v19, 0x80, v14
    s_waitcnt vmcnt(0)
    s_barrier
    s_atomic_add s87, s[88:89], 0
    s_atomic_add s87, s[88:89], 512
    s_atomic_add s87, s[88:89], 1024
    s_atomic_add s87, s[88:89], 1536
    s_atomic_add s87, s[88:89], 2048
    s_atomic_add s87, s[88:89], 2560
    s_atomic_add s87, s[88:89], 3072
    s_atomic_add s87, s[88:89], 3584
    s_add_u32 m0, s64, 81920
    s_lshl_b32 s5, s10, 5
    buffer_load_dwordx4 v22, s[36:39], s5 offen offset:0 lds
    buffer_load_dwordx4 v23, s[36:39], s5 offen offset:1024 lds
    buffer_load_dwordx4 v24, s[36:39], s5 offen offset:2048 lds
    buffer_load_dwordx4 v25, s[36:39], s5 offen offset:3072 lds
    s_add_u32 m0, s64, 98304
    s_add_u32 s5, s5, 32768
    buffer_load_dwordx4 v22, s[36:39], s5 offen offset:0 lds
    buffer_load_dwordx4 v23, s[36:39], s5 offen offset:1024 lds
    buffer_load_dwordx4 v24, s[36:39], s5 offen offset:2048 lds
    buffer_load_dwordx4 v25, s[36:39], s5 offen offset:3072 lds
    s_add_u32 m0, s64, 32768
    s_lshl_b32 s5, s11, 5
    buffer_load_dwordx4 v22, s[36:39], s5 offen offset:0 lds
    buffer_load_dwordx4 v23, s[36:39], s5 offen offset:1024 lds
    buffer_load_dwordx4 v24, s[36:39], s5 offen offset:2048 lds
    buffer_load_dwordx4 v25, s[36:39], s5 offen offset:3072 lds
    s_add_u32 m0, s64, 114688
    s_add_u32 s5, s5, 32768
    buffer_load_dwordx4 v22, s[36:39], s5 offen offset:0 lds
    buffer_load_dwordx4 v23, s[36:39], s5 offen offset:1024 lds
    buffer_load_dwordx4 v24, s[36:39], s5 offen offset:2048 lds
    buffer_load_dwordx4 v25, s[36:39], s5 offen offset:3072 lds
    s_add_u32 m0, s64, 49152
    s_lshl_b32 s5, s12, 5
    buffer_load_dwordx4 v22, s[36:39], s5 offen offset:0 lds
    buffer_load_dwordx4 v23, s[36:39], s5 offen offset:1024 lds
    buffer_load_dwordx4 v24, s[36:39], s5 offen offset:2048 lds
    buffer_load_dwordx4 v25, s[36:39], s5 offen offset:3072 lds
    s_add_u32 m0, s64, 131072
    s_add_u32 s5, s5, 32768
    buffer_load_dwordx4 v22, s[36:39], s5 offen offset:0 lds
    buffer_load_dwordx4 v23, s[36:39], s5 offen offset:1024 lds
    buffer_load_dwordx4 v24, s[36:39], s5 offen offset:2048 lds
    buffer_load_dwordx4 v25, s[36:39], s5 offen offset:3072 lds
    s_add_u32 m0, s64, 147456
    s_lshl_b32 s5, s13, 5
    buffer_load_dwordx4 v22, s[36:39], s5 offen offset:0 lds
    buffer_load_dwordx4 v23, s[36:39], s5 offen offset:1024 lds
    buffer_load_dwordx4 v24, s[36:39], s5 offen offset:2048 lds
    buffer_load_dwordx4 v25, s[36:39], s5 offen offset:3072 lds
    s_add_u32 m0, s64, 0
    s_add_u32 s5, s5, 32768
    buffer_load_dwordx4 v22, s[36:39], s5 offen offset:0 lds
    buffer_load_dwordx4 v23, s[36:39], s5 offen offset:1024 lds
    buffer_load_dwordx4 v24, s[36:39], s5 offen offset:2048 lds
    buffer_load_dwordx4 v25, s[36:39], s5 offen offset:3072 lds
    s_add_u32 m0, s64, 65536
    s_lshl_b32 s5, s14, 5
    buffer_load_dwordx4 v22, s[36:39], s5 offen offset:0 lds
    buffer_load_dwordx4 v23, s[36:39], s5 offen offset:1024 lds
    buffer_load_dwordx4 v24, s[36:39], s5 offen offset:2048 lds
    buffer_load_dwordx4 v25, s[36:39], s5 offen offset:3072 lds
    s_waitcnt lgkmcnt(0)
    s_waitcnt vmcnt(32)
    ds_read_b64_tr_b16 a[64:65], v38 offset:16384
    ds_read_b64_tr_b16 a[66:67], v38 offset:18432
    ds_read_b64_tr_b16 a[68:69], v39 offset:16384
    ds_read_b64_tr_b16 a[70:71], v39 offset:18432
    ds_read_b64_tr_b16 a[72:73], v40 offset:16384
    ds_read_b64_tr_b16 a[74:75], v40 offset:18432
    ds_read_b64_tr_b16 a[76:77], v41 offset:16384
    ds_read_b64_tr_b16 a[78:79], v41 offset:18432
    s_add_u32 m0, s64, 81920
    s_add_u32 s5, s5, 32768
    s_waitcnt lgkmcnt(0)
    buffer_load_dwordx4 v22, s[36:39], s5 offen offset:0 lds
    buffer_load_dwordx4 v23, s[36:39], s5 offen offset:1024 lds
    buffer_load_dwordx4 v24, s[36:39], s5 offen offset:2048 lds
    buffer_load_dwordx4 v25, s[36:39], s5 offen offset:3072 lds
    s_waitcnt vmcnt(32)
    ds_read_b64_tr_b16 a[80:81], v38 offset:32768
    ds_read_b64_tr_b16 a[82:83], v38 offset:34816
    ds_read_b64_tr_b16 a[84:85], v39 offset:32768
    ds_read_b64_tr_b16 a[86:87], v39 offset:34816
    ds_read_b64_tr_b16 a[88:89], v40 offset:32768
    ds_read_b64_tr_b16 a[90:91], v40 offset:34816
    ds_read_b64_tr_b16 a[92:93], v41 offset:32768
    ds_read_b64_tr_b16 a[94:95], v41 offset:34816
    s_load_dword s17, s[78:79], s65 glc
    s_mov_b32 s4, 0
    s_atomic_add s4, s[78:79], s63 glc
    buffer_load_dwordx4 v[48:51], v13, s[20:23], 0 offen
    buffer_load_dwordx4 v[52:55], v13, s[20:23], s86 offen
    s_add_u32 m0, s64, 98304
    s_waitcnt vmcnt(30)
    ds_read_b64_tr_b16 a[96:97], v34 offset:32768
    ds_read_b64_tr_b16 a[98:99], v34 offset:34816
    ds_read_b64_tr_b16 a[100:101], v35 offset:32768
    ds_read_b64_tr_b16 a[102:103], v35 offset:34816
    ds_read_b64_tr_b16 a[104:105], v36 offset:32768
    ds_read_b64_tr_b16 a[106:107], v36 offset:34816
    ds_read_b64_tr_b16 a[108:109], v37 offset:32768
    ds_read_b64_tr_b16 a[110:111], v37 offset:34816
    s_waitcnt vmcnt(26)
    ds_read_b64_tr_b16 a[112:113], v38 offset:49152
    ds_read_b64_tr_b16 a[114:115], v38 offset:51200
    ds_read_b64_tr_b16 a[116:117], v39 offset:49152
    ds_read_b64_tr_b16 a[118:119], v39 offset:51200
    ds_read_b64_tr_b16 a[120:121], v40 offset:49152
    ds_read_b64_tr_b16 a[122:123], v40 offset:51200
    ds_read_b64_tr_b16 a[124:125], v41 offset:49152
    ds_read_b64_tr_b16 a[126:127], v41 offset:51200
    s_waitcnt vmcnt(22)
    ds_read_b64_tr_b16 a[128:129], v34 offset:49152
    ds_read_b64_tr_b16 a[130:131], v34 offset:51200
    ds_read_b64_tr_b16 a[132:133], v35 offset:49152
    ds_read_b64_tr_b16 a[134:135], v35 offset:51200
    ds_read_b64_tr_b16 a[136:137], v36 offset:49152
    ds_read_b64_tr_b16 a[138:139], v36 offset:51200
    ds_read_b64_tr_b16 a[140:141], v37 offset:49152
    ds_read_b64_tr_b16 a[142:143], v37 offset:51200
    s_waitcnt lgkmcnt(0)
    s_cmp_ge_u32 s17, 8
    s_cbranch_scc0 Ldg_slow
Ldg_ok:
    buffer_load_dwordx4 v26, s[32:35], 0 offen offset:0 sc1 lds
    buffer_load_dwordx4 v27, s[32:35], 0 offen offset:1024 sc1 lds
    buffer_load_dwordx4 v28, s[32:35], 0 offen offset:2048 sc1 lds
    buffer_load_dwordx4 v29, s[32:35], 0 offen offset:3072 sc1 lds
    s_cmp_ge_u32 s4, 14
    s_cbranch_scc1 Ldh_ok
    s_mov_b32 s62, 0
Ldh_spin:
    s_mov_b32 s4, 0
    s_atomic_add s4, s[78:79], s63 glc
    s_add_u32 s62, s62, 1
    s_waitcnt lgkmcnt(0)
    s_cmp_ge_u32 s4, 14
    s_cbranch_scc1 Ldh_ok
    s_cmp_lt_u32 s62, 0x40000
    s_cbranch_scc1 Ldh_spin
Ldh_ok:
    buffer_load_dwordx4 v[128:131], v30, s[32:35], s8 offen offset:0 sc1
    buffer_load_dwordx4 v[132:135], v30, s[32:35], s8 offen offset:1024 sc1
    buffer_load_dwordx4 v[136:139], v30, s[32:35], s9 offen offset:0 sc1
    s_waitcnt vmcnt(25)
    ds_read_b64_tr_b16 a[144:145], v42 offset:0
    ds_read_b64_tr_b16 a[146:147], v42 offset:2048
    ds_read_b64_tr_b16 a[148:149], v43 offset:0
    ds_read_b64_tr_b16 a[150:151], v43 offset:2048
    ds_read_b64_tr_b16 a[152:153], v44 offset:0
    ds_read_b64_tr_b16 a[154:155], v44 offset:2048
    buffer_load_dwordx4 v[140:143], v30, s[32:35], s9 offen offset:1024 sc1
    ds_read_b64_tr_b16 a[156:157], v45 offset:0
    ds_read_b64_tr_b16 a[158:159], v45 offset:2048
    s_waitcnt vmcnt(22)
    ds_read_b64_tr_b16 a[160:161], v42 offset:16384
    ds_read_b64_tr_b16 a[162:163], v42 offset:18432
    ds_read_b64_tr_b16 a[164:165], v43 offset:16384
    ds_read_b64_tr_b16 a[166:167], v43 offset:18432
    ds_read_b64_tr_b16 a[168:169], v44 offset:16384
    ds_read_b64_tr_b16 a[170:171], v44 offset:18432
    ds_read_b64_tr_b16 a[172:173], v45 offset:16384
    ds_read_b64_tr_b16 a[174:175], v45 offset:18432
    s_waitcnt vmcnt(18)
    ds_read_b64_tr_b16 a[176:177], v34 offset:0
    ds_read_b64_tr_b16 a[178:179], v34 offset:2048
    buffer_load_dwordx4 v[144:147], v30, s[32:35], s10 offen offset:0 sc1
    ds_read_b64_tr_b16 a[180:181], v35 offset:0
    ds_read_b64_tr_b16 a[182:183], v35 offset:2048
    ds_read_b64_tr_b16 a[184:185], v36 offset:0
    ds_read_b64_tr_b16 a[186:187], v36 offset:2048
    ds_read_b64_tr_b16 a[188:189], v37 offset:0
    ds_read_b64_tr_b16 a[190:191], v37 offset:2048
    s_waitcnt vmcnt(15)
    ds_read_b64_tr_b16 a[192:193], v38 offset:0
    ds_read_b64_tr_b16 a[194:195], v38 offset:2048
    ds_read_b64_tr_b16 a[196:197], v39 offset:0
    ds_read_b64_tr_b16 a[198:199], v39 offset:2048
Lpad_d2:
    s_cbranch_execz Lret_d
    ds_read_b64_tr_b16 a[200:201], v40 offset:0
    ds_read_b64_tr_b16 a[202:203], v40 offset:2048
    buffer_load_dwordx4 v[148:151], v30, s[32:35], s10 offen offset:1024 sc1
    ds_read_b64_tr_b16 a[204:205], v41 offset:0
    ds_read_b64_tr_b16 a[206:207], v41 offset:2048
    s_waitcnt vmcnt(12)
    ds_read_b64_tr_b16 a[208:209], v38 offset:16384
    ds_read_b64_tr_b16 a[210:211], v38 offset:18432
    ds_read_b64_tr_b16 a[212:213], v39 offset:16384
    ds_read_b64_tr_b16 a[214:215], v39 offset:18432
    ds_read_b64_tr_b16 a[216:217], v40 offset:16384
    ds_read_b64_tr_b16 a[218:219], v40 offset:18432
    ds_read_b64_tr_b16 a[220:221], v41 offset:16384
    ds_read_b64_tr_b16 a[222:223], v41 offset:18432
    s_waitcnt vmcnt(11)
    v_permlane16_swap_b32 v48, v50
    v_permlane16_swap_b32 v49, v51
    buffer_load_dwordx4 v[152:155], v30, s[32:35], s11 offen offset:0 sc1
    s_waitcnt vmcnt(11)
    v_permlane16_swap_b32 v52, v54
    v_permlane16_swap_b32 v53, v55
    v_lshlrev_b32 v64, 16, v48
    v_and_b32 v65, s3, v48
    v_lshlrev_b32 v66, 16, v49
    v_and_b32 v67, s3, v49
    v_lshlrev_b32 v68, 16, v50
    v_and_b32 v69, s3, v50
    v_lshlrev_b32 v70, 16, v51
    v_and_b32 v71, s3, v51
    v_lshlrev_b32 v72, 16, v52
    v_and_b32 v73, s3, v52
    buffer_load_dwordx4 v[156:159], v30, s[32:35], s11 offen offset:1024 sc1
    v_lshlrev_b32 v74, 16, v53
    v_and_b32 v75, s3, v53
    v_lshlrev_b32 v76, 16, v54
    v_and_b32 v77, s3, v54
    v_lshlrev_b32_e64 v78, 16, v55
    v_and_b32 v79, s3, v55
    s_waitcnt vmcnt(8)
    s_waitcnt lgkmcnt(0)
    s_branch L_phaseB
Lgz_rare:
    s_atomic_add s87, s[76:77], 0
    s_branch Lgz_done
Lgi_slow:
    s_mov_b32 s62, 0
Lgi_spin:
    global_load_dword v46, v11, s[76:77] sc1
    s_waitcnt vmcnt(0)
    v_readfirstlane_b32 s4, v46
    s_nop 3
    s_add_u32 s62, s62, 1
    s_waitcnt lgkmcnt(0)
    s_cmp_ge_u32 s4, 8
    s_cbranch_scc1 Lgi_ok
    s_cmp_lt_u32 s62, 0x40000
    s_cbranch_scc1 Lgi_spin
    s_branch Lgi_ok
Lgs_slow:
    s_mov_b32 s62, 0
Lgs_spin:
    s_load_dword s4, s[78:79], s56 glc
    s_add_u32 s62, s62, 1
    s_waitcnt lgkmcnt(0)
    s_cmp_ge_u32 s4, s53
    s_cbranch_scc1 Lgs_ok
    s_cmp_lt_u32 s62, 0x40000
    s_cbranch_scc1 Lgs_spin
    s_branch Lgs_ok
Lgg_slow:
    s_waitcnt lgkmcnt(0)
    s_cmp_ge_u32 s17, 8
    s_cbranch_scc1 Lgg_ok
    s_mov_b32 s62, 0
Lgg_spin:
    s_load_dword s17, s[78:79], s65 glc
    s_add_u32 s62, s62, 1
    s_waitcnt lgkmcnt(0)
    s_cmp_ge_u32 s17, 8
    s_cbranch_scc1 Lgg_ok
    s_cmp_lt_u32 s62, 0x40000
    s_cbranch_scc1 Lgg_spin
    s_branch Lgg_ok
Ll_slow:
    s_mov_b32 s62, 0
Ll_spin:
    s_mov_b32 s4, 0
    s_atomic_add s4, s[78:79], s61 glc
    s_add_u32 s62, s62, 1
    s_waitcnt lgkmcnt(0)
    s_cmp_ge_u32 s4, 14
    s_cbranch_scc1 Ll_ok
    s_cmp_lt_u32 s62, 0x40000
    s_cbranch_scc1 Ll_spin
    s_branch Ll_ok
Ldi_slow:
    s_mov_b32 s62, 0
Ldi_spin:
    global_load_dword v46, v11, s[76:77] sc1
    s_waitcnt vmcnt(0)
    v_readfirstlane_b32 s4, v46
    s_nop 3
    s_add_u32 s62, s62, 1
    s_waitcnt lgkmcnt(0)
    s_cmp_ge_u32 s4, 8
    s_cbranch_scc1 Ldi_ok
    s_cmp_lt_u32 s62, 0x40000
    s_cbranch_scc1 Ldi_spin
    s_branch Ldi_ok
Lds_slow:
    s_mov_b32 s62, 0
Lds_spin:
    s_load_dword s4, s[78:79], s58 glc
    s_add_u32 s62, s62, 1
    s_waitcnt lgkmcnt(0)
    s_cmp_ge_u32 s4, 8
    s_cbranch_scc1 Lds_ok
    s_cmp_lt_u32 s62, 0x40000
    s_cbranch_scc1 Lds_spin
    s_branch Lds_ok
Ldg_slow:
    s_mov_b32 s62, 0
Ldg_spin:
    s_load_dword s17, s[78:79], s65 glc
    s_add_u32 s62, s62, 1
    s_waitcnt lgkmcnt(0)
    s_cmp_ge_u32 s17, 8
    s_cbranch_scc1 Ldg_ok
    s_cmp_lt_u32 s62, 0x40000
    s_cbranch_scc1 Ldg_spin
    s_branch Ldg_ok
L_code_end:
.fill 64, 4, 0xbf810000
.section .rodata,"a"
.p2align 6
.amdhsa_kernel parallel_sum__spectral_fnet__glu_gated_glu__prompt_kernel
  .amdhsa_next_free_vgpr 512
  .amdhsa_next_free_sgpr 102
  .amdhsa_accum_offset 256
  .amdhsa_group_segment_fixed_size 0
  .amdhsa_kernarg_size 96
  .amdhsa_user_sgpr_count 2
  .amdhsa_user_sgpr_kernarg_segment_ptr 1
  .amdhsa_system_sgpr_workgroup_id_x 1
.end_amdhsa_kernel
```
